```python
import torch

def _softmax(x, axis=-1):
    return torch.softmax(x, dim=axis)

def _gelu(x):
    return torch.nn.functional.gelu(x, approximate='tanh')

def _silu(x):
    return torch.nn.functional.silu(x)

def _sigmoid(x):
    return torch.sigmoid(x)

def _layernorm(x, axis=-1, eps=1e-05):
    m = x.mean(dim=axis, keepdim=True)
    v = x.var(dim=axis, keepdim=True, unbiased=False)
    return (x - m) / torch.sqrt(v + eps)

def _scatter_add(tgt, idx, src, axis=0):
    return tgt.clone().index_add_(axis, idx, src)

def _segment_sum(src, seg, n):
    out = torch.zeros((n,) + src.shape[1:], dtype=src.dtype)
    return out.index_add_(0, seg, src)

def _pad(x, pw):
    flat = tuple((v for pair in reversed(pw) for v in pair))
    return torch.nn.functional.pad(x, flat)
kernel_name = 'standalone__swin_window_attn__vision'

def setup_inputs():

    _w = lambda a: (lambda t: t.to(torch.bfloat16) if t.is_floating_point() else t)(torch.as_tensor(a))
    H = W = 384 // 7 * 7
    C, win = (96, 7)
    return {'x': _w((lambda *s: torch.randn(*s, dtype=torch.bfloat16) * 0.4)(1, H, W, C)), 'wqkv': _w((lambda *s: torch.randn(*s, dtype=torch.bfloat16) * 0.4)(C, 3 * C)), 'wo': _w((lambda *s: torch.randn(*s, dtype=torch.bfloat16) * 0.05)(C, C))}

def reference(x, wqkv, wo):
    B, H, W, C = x.shape
    win = 7
    nh, nw = (H // win, W // win)
    xw = (lambda x, *d: x.permute(*d))(x.reshape(B, nh, win, nw, win, C), 0, 1, 3, 2, 4, 5)
    xw = xw.reshape(B * nh * nw, win * win, C)
    qkv = xw @ wqkv
    q, k, v = (qkv[..., :C].clone(), qkv[..., C:2 * C].clone(), qkv[..., 2 * C:].clone())
    scale = C ** (-0.5)
    p = _softmax(torch.einsum('bqc,bkc->bqk', q, k) * scale, axis=-1)
    o = torch.einsum('bqk,bkc->bqc', p, v) @ wo
    o = (lambda x, *d: x.permute(*d))(o.reshape(B, nh, nw, win, win, C), 0, 1, 3, 2, 4, 5)
    return o.reshape(B, H, W, C)
```

```asm
; @launch grid=(251,1,1) block=(256,1,1) lds=158784
.amdgcn_target "amdgcn-amd-amdhsa--gfx950"
.text
.p2align 12
L_anchor:
.globl standalone__swin_window_attn__vision_kernel
.p2align 8
.type standalone__swin_window_attn__vision_kernel,@function
standalone__swin_window_attn__vision_kernel:
L_start:
    s_load_dwordx4 s[4:7], s[0:1], 0
    s_load_dwordx4 s[8:11], s[0:1], 16
    s_sub_u32 s2, s2, 8
    s_cmp_ge_u32 s2, 243
    s_cbranch_scc1 L_help
    v_lshrrev_b32 v20, 6, v0
    s_nop 0
    v_readfirstlane_b32 s28, v20
    v_and_b32 v0, 63, v0
    v_lshlrev_b32 v3, 4, v0
    s_and_b32 s44, s28, 1
    s_lshr_b32 s45, s28, 1
    s_cbranch_scc0 L_hops
    v_lshrrev_b32 v22, 3, v0
    v_mul_u32_u24 v22, 43, v22
    s_lshl_b32 s40, s44, 5
    v_xor_b32 v23, s40, v3
    s_movk_i32 s41, 64
    s_movk_i32 s42, 192
    v_lshrrev_b32 v27, 2, v22
    v_lshrrev_b32 v28, 7, v22
    v_bitop3_b32 v27, v27, s41, v23 bitop3:0x6a
    v_mad_u32_u24 v250, v28, s42, v27
    v_add_u32 v22, 344, v22
    v_lshrrev_b32 v27, 2, v22
    v_lshrrev_b32 v28, 7, v22
    v_bitop3_b32 v27, v27, s41, v23 bitop3:0x6a
    v_mad_u32_u24 v251, v28, s42, v27
    v_add_u32 v22, 344, v22
    v_lshrrev_b32 v27, 2, v22
    v_lshrrev_b32 v28, 7, v22
    v_bitop3_b32 v27, v27, s41, v23 bitop3:0x6a
    v_mad_u32_u24 v252, v28, s42, v27
    s_mov_b32 s22, 55296
    s_mov_b32 s23, 0x20000
    s_mul_i32 s46, s44, 4608
    s_mul_i32 s47, s44, 3072
    s_add_u32 m0, s47, 0
    s_mov_b32 s14, 27433728
    s_mov_b32 s15, 0x20000
    s_lshl_b32 s40, s2, 2
    s_add_u32 s40, s40, s28
    s_mul_i32 s41, s40, 1214
    s_lshr_b32 s41, s41, 16
    s_mul_i32 s41, s41, 435456
    s_mul_i32 s40, s40, 1344
    s_add_u32 s37, s40, s41
    s_add_u32 s61, s37, 436608
    s_mul_i32 s60, s28, 9216
    s_add_u32 s60, s60, 37248
    v_lshrrev_b32 v29, 2, v0
    v_mul_u32_u24 v29, 43, v29
    v_lshrrev_b32 v22, 7, v29
    s_mov_b32 s41, 9144384
    v_mad_u32_u24 v30, v22, s41, v3
    s_mul_i32 s39, s28, 576
    s_add_u32 s39, s39, 156480
    s_waitcnt lgkmcnt(0)
    s_mov_b32 s20, s6
    s_mov_b32 s21, s7
    buffer_load_dwordx4 v250, s[20:23], s46 offen offset:0 lds
    v_lshrrev_b32 v21, 4, v0
    v_mul_u32_u24 v22, 43, v21
    buffer_load_dwordx4 v251, s[20:23], s46 offen offset:1024 lds
    s_mov_b32 s41, 0x30
    v_lshrrev_b32 v23, 3, v22
    buffer_load_dwordx4 v252, s[20:23], s46 offen offset:2048 lds
    v_bitop3_b32 v4, v23, s41, v3 bitop3:0x6a
    v_add_u32 v24, 0x11640, v4
    s_add_u32 m0, s47, 6144
    s_add_u32 s46, s46, 9216
    buffer_load_dwordx4 v250, s[20:23], s46 offen offset:0 lds
    v_add_u32 v22, 172, v22
    v_lshrrev_b32 v23, 3, v22
    buffer_load_dwordx4 v251, s[20:23], s46 offen offset:1024 lds
    v_bitop3_b32 v8, v23, s41, v3 bitop3:0x6a
    v_add_u32 v25, 0x11640, v8
    buffer_load_dwordx4 v252, s[20:23], s46 offen offset:2048 lds
    v_add_u32 v22, 172, v22
    v_lshrrev_b32 v23, 3, v22
    s_add_u32 m0, s47, 12288
    s_add_u32 s46, s46, 9216
    buffer_load_dwordx4 v250, s[20:23], s46 offen offset:0 lds
    v_bitop3_b32 v12, v23, s41, v3 bitop3:0x6a
    v_add_u32 v26, 0x11640, v12
    buffer_load_dwordx4 v251, s[20:23], s46 offen offset:1024 lds
    s_lshl_b64 s[42:43], -1, 20
    v_cndmask_b32 v5, v8, v25, s[42:43]
    buffer_load_dwordx4 v252, s[20:23], s46 offen offset:2048 lds
    s_lshl_b64 s[42:43], -1, 40
    v_cndmask_b32 v6, v12, v26, s[42:43]
    s_add_u32 m0, s47, 18432
    s_add_u32 s46, s46, 9216
    buffer_load_dwordx4 v250, s[20:23], s46 offen offset:0 lds
    s_lshl_b64 s[42:43], -1, 60
    v_cndmask_b32 v7, v4, v24, s[42:43]
    buffer_load_dwordx4 v251, s[20:23], s46 offen offset:1024 lds
    s_lshl_b64 s[42:43], -1, 16
    v_cndmask_b32 v9, v12, v26, s[42:43]
    buffer_load_dwordx4 v252, s[20:23], s46 offen offset:2048 lds
    s_lshl_b64 s[42:43], -1, 36
    v_cndmask_b32 v10, v4, v24, s[42:43]
    s_add_u32 m0, s47, 24576
    s_add_u32 s46, s46, 9216
    buffer_load_dwordx4 v250, s[20:23], s46 offen offset:0 lds
    s_lshl_b64 s[42:43], -1, 56
    v_cndmask_b32 v11, v8, v25, s[42:43]
    buffer_load_dwordx4 v251, s[20:23], s46 offen offset:1024 lds
    buffer_load_dwordx4 v252, s[20:23], s46 offen offset:2048 lds
    s_add_u32 m0, s47, 30720
    s_add_u32 s46, s46, 9216
    buffer_load_dwordx4 v250, s[20:23], s46 offen offset:0 lds
    buffer_load_dwordx4 v251, s[20:23], s46 offen offset:1024 lds
    buffer_load_dwordx4 v252, s[20:23], s46 offen offset:2048 lds
    s_branch L_join
L_help:
    s_cmp_lt_u32 s2, 4294967288
    s_cbranch_scc1 L_end
    s_getpc_b64 s[44:45]
L_pch:
    s_sub_u32 s44, s44, L_pch-L_start
    s_subb_u32 s45, s45, 0
    v_lshlrev_b32 v1, 7, v0
    v_min_u32 v24, L_fin-L_start, v1
    v_mov_b32 v25, s45
    v_add_co_u32 v24, vcc, s44, v24
    s_nop 1
    v_addc_co_u32 v25, vcc, 0, v25, vcc
    global_load_dword v26, v[24:25], off
    s_mov_b32 s22, 55296
    s_mov_b32 s23, 0x20000
    s_movk_i32 s26, 18432
    s_mov_b32 s27, 0x20000
    s_mov_b32 s40, 32768
    s_and_b32 s41, s2, 7
    s_lshl_b32 s41, s41, 2
    v_lshrrev_b32 v2, 3, v0
    v_bfe_u32 v3, v0, 1, 2
    v_lshl_add_u32 v2, v2, 5, v3
    v_add_u32 v2, s41, v2
    v_min_u32 v2, 971, v2
    v_mul_u32_u24 v3, 1214, v2
    v_lshrrev_b32 v3, 16, v3
    v_mul_u32_u24 v3, 435456, v3
    v_mul_u32_u24 v2, 1344, v2
    v_and_b32 v4, 1, v0
    v_lshlrev_b32 v4, 7, v4
    v_add3_u32 v2, v2, v3, v4
    s_mov_b32 s14, 27433728
    s_mov_b32 s15, 0x20000
    s_mov_b32 s41, 436608
    s_mov_b32 s42, 9581184
    s_mov_b32 s43, 18725760
    s_waitcnt lgkmcnt(0)
    s_mov_b32 s20, s6
    s_mov_b32 s21, s7
    s_mov_b32 s24, s8
    s_mov_b32 s25, s9
    buffer_load_dword v27, v1, s[20:23], 0 offen
    buffer_load_dword v28, v1, s[20:23], s40 offen
    s_mov_b32 s12, s4
    s_mov_b32 s13, s5
    buffer_load_dword v30, v2, s[12:15], s41 offen
    buffer_load_dword v31, v2, s[12:15], s42 offen
    buffer_load_dword v32, v2, s[12:15], s43 offen
    buffer_load_dword v29, v1, s[24:27], 0 offen
    s_endpgm
L_hops:
    s_mov_b64 exec, 0
    s_cmp_eq_u32 s28, 0
    s_cbranch_scc1 L_h0
    s_branch L_h1
L_hopret:
    s_mov_b64 exec, -1
    s_mov_b32 s14, 27433728
    s_mov_b32 s15, 0x20000
    s_lshl_b32 s40, s2, 2
    s_add_u32 s40, s40, s28
    s_mul_i32 s41, s40, 1214
    s_lshr_b32 s41, s41, 16
    s_mul_i32 s41, s41, 435456
    s_mul_i32 s40, s40, 1344
    s_add_u32 s37, s40, s41
    s_add_u32 s61, s37, 436608
    s_mul_i32 s60, s28, 9216
    s_add_u32 s60, s60, 37248
    v_lshrrev_b32 v29, 2, v0
    v_mul_u32_u24 v29, 43, v29
    v_lshrrev_b32 v22, 7, v29
    s_mov_b32 s41, 9144384
    v_mad_u32_u24 v30, v22, s41, v3
    s_mul_i32 s39, s28, 576
    s_add_u32 s39, s39, 156480
    v_lshrrev_b32 v21, 4, v0
    v_mul_u32_u24 v22, 43, v21
    s_mov_b32 s41, 0x30
    v_lshrrev_b32 v23, 3, v22
    v_bitop3_b32 v4, v23, s41, v3 bitop3:0x6a
    v_add_u32 v24, 0x11640, v4
    v_add_u32 v22, 172, v22
    v_lshrrev_b32 v23, 3, v22
    v_bitop3_b32 v8, v23, s41, v3 bitop3:0x6a
    v_add_u32 v25, 0x11640, v8
    v_add_u32 v22, 172, v22
    v_lshrrev_b32 v23, 3, v22
    v_bitop3_b32 v12, v23, s41, v3 bitop3:0x6a
    v_add_u32 v26, 0x11640, v12
    s_lshl_b64 s[42:43], -1, 20
    v_cndmask_b32 v5, v8, v25, s[42:43]
    s_lshl_b64 s[42:43], -1, 40
    v_cndmask_b32 v6, v12, v26, s[42:43]
    s_lshl_b64 s[42:43], -1, 60
    v_cndmask_b32 v7, v4, v24, s[42:43]
    s_lshl_b64 s[42:43], -1, 16
    v_cndmask_b32 v9, v12, v26, s[42:43]
    s_lshl_b64 s[42:43], -1, 36
    v_cndmask_b32 v10, v4, v24, s[42:43]
    s_lshl_b64 s[42:43], -1, 56
    v_cndmask_b32 v11, v8, v25, s[42:43]
    s_waitcnt lgkmcnt(0)
L_join:
    v_and_b32 v25, 3, v0
    v_bfe_u32 v23, v0, 2, 2
    v_lshl_add_u32 v22, v23, 3, v25
    v_lshlrev_b32 v23, 1, v23
    v_bitop3_b32 v23, v23, 2, v21 bitop3:0x6a
    v_lshlrev_b32 v23, 4, v23
    s_movk_i32 s40, 384
    v_mad_u32_u24 v22, v22, s40, v23
    v_and_b32 v23, 2, v0
    v_lshlrev_b32 v23, 5, v23
    v_add_u32 v24, v22, v23
    v_sub_u32 v26, v22, v23
    s_mul_i32 s46, s44, 1536
    s_add_u32 s46, s46, 0
    v_add_u32 v13, s46, v24
    v_add_u32 v14, s46, v26
    s_mul_i32 s46, s45, 1536
    s_add_u32 s46, s46, 0
    v_add_u32 v15, s46, v24
    v_add_u32 v16, s46, v26
    v_lshrrev_b32 v23, 2, v0
    v_bitop3_b32 v23, v23, 8, v0 bitop3:0x6a
    v_lshlrev_b32 v1, 4, v23
    v_lshrrev_b32 v22, 4, v0
    s_movk_i32 s40, 192
    v_and_b32 v23, 3, v0
    v_bfe_u32 v24, v0, 2, 2
    v_lshl_add_u32 v24, v23, 2, v24
    v_xor_b32 v2, v22, v23
    v_lshl_add_u32 v2, v2, 4, s60
    v_mad_u32_u24 v2, v24, s40, v2
    s_mul_i32 s46, s45, 3072
    s_lshl_b32 s47, s44, 3
    s_add_u32 s46, s46, s47
    v_add_u32 v243, 110976, v1
    v_add_u32 v17, s46, v243
    s_mov_b32 s49, 0x3e16c740
    s_lshl_b32 s43, s44, 1
    s_movk_i32 s42, 192
    s_movk_i32 s26, 18432
    s_movk_i32 s48, 3072
    s_mov_b32 m0, s39
    s_mov_b32 s12, s4
    s_mov_b32 s13, s5
    s_bfm_b64 exec, 36, 0
    buffer_load_dwordx4 v30, s[12:15], s61 offen lds
    s_mov_b64 exec, -1
    s_add_u32 m0, s60, 0
    s_add_u32 s41, s37, 0
    buffer_load_dwordx4 v4, s[12:15], s41 offen offset:0 nt lds
    s_add_u32 s41, s37, 0
    buffer_load_dwordx4 v5, s[12:15], s41 offen offset:1024 nt lds
    s_cmp_lt_u32 s28, 2
    s_cselect_b32 s42, 576, s42
    s_cselect_b32 s43, s43, 0
    s_cselect_b32 s26, 55296, s26
    s_cselect_b32 s48, 9216, s48
    s_cselect_b32 s3, 384, 0
    s_cselect_b32 s24, s6, s8
    s_cselect_b32 s25, s7, s9
    s_mov_b32 s27, 0x20000
    v_lshrrev_b32 v27, 5, v29
    v_lshrrev_b32 v28, 7, v29
    v_bitop3_b32 v27, v27, 32, v3 bitop3:0x6a
    v_xor_b32 v22, s43, v28
    v_mad_u32_u24 v27, v22, s42, v27
    v_mul_u32_u24 v28, 0xc0, v28
    v_sub_u32 v240, v27, v28
    v_add_u32 v29, 688, v29
    v_lshrrev_b32 v27, 5, v29
    v_lshrrev_b32 v28, 7, v29
    v_bitop3_b32 v27, v27, 32, v3 bitop3:0x6a
    v_xor_b32 v22, s43, v28
    v_mad_u32_u24 v27, v22, s42, v27
    v_mul_u32_u24 v28, 0xc0, v28
    v_sub_u32 v241, v27, v28
    v_add_u32 v29, 688, v29
    v_lshrrev_b32 v27, 5, v29
    v_lshrrev_b32 v28, 7, v29
    v_bitop3_b32 v27, v27, 32, v3 bitop3:0x6a
    v_xor_b32 v22, s43, v28
    v_mad_u32_u24 v27, v22, s42, v27
    v_mul_u32_u24 v28, 0xc0, v28
    v_sub_u32 v242, v27, v28
    s_mul_i32 s40, s44, s48
    s_add_u32 s3, s3, s40
    s_lshl_b32 s48, s48, 1
    s_mul_i32 s29, s45, 18432
    s_mul_i32 s40, s44, 3072
    s_add_u32 s29, s29, s40
    s_add_u32 s92, s3, s48
    s_add_u32 s93, s92, s48
    s_min_u32 s43, s28, 2
    v_and_b32 v20, 15, v0
    v_min_u32 v24, 11, v20
    v_and_b32 v26, 48, v0
    v_and_b32 v22, 3, v24
    v_mul_u32_u24 v22, 576, v22
    v_lshrrev_b32 v23, 2, v24
    v_mul_u32_u24 v23, 0xc0, v23
    v_add3_u32 v22, v22, v23, v26
    v_add_u32 v244, 156480, v22
    s_lshl_b32 s40, s43, 6
    v_add_u32 v245, s40, v244
    s_mul_i32 s42, s43, 6144
    v_add_u32 v246, s42, v243
    v_lshlrev_b32 v22, 8, v25
    v_lshrrev_b32 v23, 2, v0
    v_lshlrev_b32 v27, 2, v0
    v_bitop3_b32 v23, v27, 8, v23 bitop3:0x6a
    v_lshl_add_u32 v22, v23, 4, v22
    s_lshl_b32 s42, s43, 10
    s_add_u32 s42, s42, 110976
    v_add_u32 v247, s42, v22
    s_add_u32 s42, s40, 147840
    v_mul_u32_u24 v24, 720, v24
    v_add3_u32 v248, v24, v26, s42
    s_lshl_b32 s42, s43, 2
    v_mov_b32 v22, s42
    s_mov_b32 vcc_lo, 0x00f0000f
    s_mov_b32 vcc_hi, 0xf0000f00
    v_cndmask_b32 v22, 12, v22, vcc
    s_mov_b32 s42, 148544
    v_add3_u32 v249, v24, v22, s42
    s_mov_b32 s16, s10
    s_mov_b32 s17, s11
    s_mov_b32 s18, 27433728
    s_mov_b32 s19, 0x20000
    s_mul_i32 s38, s28, 720
    s_add_u32 s38, s38, 147840
    s_mov_b32 s30, s37
    s_add_u32 s41, s37, 71232
    buffer_load_dwordx4 v6, s[12:15], s41 offen offset:2048 nt lds
    s_movk_i32 s40, 192
    v_lshrrev_b32 v164, 4, v0
    v_and_b32 v165, 3, v0
    v_bfe_u32 v166, v0, 2, 2
    v_lshl_add_u32 v167, v165, 3, s39
    v_lshlrev_b32 v168, 1, v166
    v_xor_b32 v168, v168, v165
    s_add_u32 s41, s37, 142464
    buffer_load_dwordx4 v7, s[12:15], s41 offen offset:3072 nt lds
    v_lshl_add_u32 v165, v168, 3, s60
    v_lshl_add_u32 v168, v166, 2, v164
    v_mad_u32_u24 v165, v168, s40, v165
    v_xor_b32 v166, 32, v165
    v_lshl_add_u32 v168, v164, 4, s38
    v_and_b32 v169, 1, v0
    v_mad_u32_u24 v168, v169, s40, v168
    s_add_u32 m0, s60, 4096
    s_add_u32 s41, s37, 217792
    buffer_load_dwordx4 v8, s[12:15], s41 offen offset:0 nt lds
    v_and_b32 v169, 15, v0
    v_mov_b32 v170, s38
    v_lshl_add_u32 v171, v0, 1, s38
    v_lshl_add_u32 v172, v164, 3, s38
    v_lshl_add_u32 v173, v169, 2, s38
    v_add_u32 v174, 73728, v2
    v_add_u32 v175, 73728, v165
    s_add_u32 s41, s37, 217792
    buffer_load_dwordx4 v9, s[12:15], s41 offen offset:1024 nt lds
    v_add_u32 v176, 73728, v166
    v_mov_b32 v180, 0x3f803f80
    v_mov_b32 v181, 0x3f803f80
    v_mov_b32 v182, 0x3f803f80
    v_mov_b32 v183, 0x3f803f80
    v_mov_b32 v187, 0
    v_mov_b32 v191, 0
    s_add_u32 s41, s37, 289024
    buffer_load_dwordx4 v10, s[12:15], s41 offen offset:2048 nt lds
    v_mov_b32 v195, 0
    v_mov_b32 v177, 0xff800000
    v_mul_u32_u24 v178, 12, v0
    v_add_u32 v179, 0x11640, v178
    s_mov_b64 s[50:51], 0xffff
    s_lshl_b64 s[52:53], s[50:51], 16
    s_lshl_b64 s[54:55], s[50:51], 32
    s_add_u32 s41, s37, 360256
    buffer_load_dwordx4 v11, s[12:15], s41 offen offset:3072 nt lds
    s_lshl_b64 s[56:57], 1, 48
    v_cndmask_b32 v196, v179, v178, s[50:51]
    v_cndmask_b32 v179, v196, v178, s[52:53]
    v_cndmask_b32 v197, v179, v178, s[54:55]
    s_add_u32 s31, s30, 72576
    s_add_u32 s32, s30, 145152
    s_add_u32 s33, s30, 217728
    s_add_u32 m0, s60, 8192
    s_add_u32 s41, s37, 435584
    buffer_load_dwordx4 v12, s[12:15], s41 offen offset:0 nt lds
    s_add_u32 s34, s30, 290304
    s_add_u32 s35, s30, 362880
    s_add_u32 s36, s30, 435456
    v_and_b32 v198, 1, v0
    v_xor_b32 v199, s44, v198
    v_lshlrev_b32 v198, 4, v198
    v_lshl_add_u32 v198, v199, 1, v198
    v_and_b32 v199, 12, v0
    v_bfe_u32 v200, v0, 1, 1
    v_add3_u32 v198, v198, v199, v200
    v_lshrrev_b32 v201, 2, v0
    v_bitop3_b32 v199, v201, 2, v164 bitop3:0x6a
    s_mov_b32 s46, 0
    v_lshl_add_u32 v199, v199, 4, s46
    v_mad_u32_u24 v202, v198, s40, v199
    v_bfe_u32 v198, v0, 2, 2
    v_lshl_add_u32 v198, v164, 3, v198
    v_xor_b32 v199, s45, v164
    s_waitcnt vmcnt(10)
    s_barrier
    ds_read_b128 v[32:35], v13 offset:0
    ds_read_b128 v[36:39], v14 offset:64
    ds_read_b128 v[40:43], v13 offset:128
    ds_read_b128 v[44:47], v16 offset:192
    ds_read_b128 v[48:51], v15 offset:256
    ds_read_b128 v[52:55], v16 offset:320
    ds_read_b128 v[56:59], v16 offset:12480
    ds_read_b128 v[60:63], v15 offset:12544
    ds_read_b128 v[64:67], v16 offset:12608
    ds_read_b128 v[68:71], v13 offset:12288
    ds_read_b128 v[72:75], v14 offset:12352
    ds_read_b128 v[76:79], v13 offset:12416
    ds_read_b128 v[80:83], v16 offset:24768
    ds_read_b128 v[84:87], v15 offset:24832
    ds_read_b128 v[88:91], v16 offset:24896
    s_waitcnt lgkmcnt(11)
    v_mfma_f32_16x16x32_bf16 v[92:95], v[32:35], v[44:47], 0
    ds_read_b128 v[96:99], v13 offset:24576
    s_waitcnt lgkmcnt(11)
    v_mfma_f32_16x16x32_bf16 v[92:95], v[36:39], v[48:51], v[92:95]
    ds_read_b128 v[100:103], v14 offset:24640
    s_waitcnt lgkmcnt(11)
    v_mfma_f32_16x16x32_bf16 v[92:95], v[40:43], v[52:55], v[92:95]
    ds_read_b128 v[104:107], v13 offset:24704
    s_waitcnt lgkmcnt(11)
    v_mfma_f32_16x16x32_bf16 v[108:111], v[32:35], v[56:59], 0
    s_waitcnt lgkmcnt(10)
    v_mfma_f32_16x16x32_bf16 v[108:111], v[36:39], v[60:63], v[108:111]
    s_waitcnt lgkmcnt(9)
    v_mfma_f32_16x16x32_bf16 v[108:111], v[40:43], v[64:67], v[108:111]
    s_waitcnt lgkmcnt(8)
    v_mfma_f32_16x16x32_bf16 v[112:115], v[68:71], v[44:47], 0
    s_waitcnt lgkmcnt(7)
    v_mfma_f32_16x16x32_bf16 v[112:115], v[72:75], v[48:51], v[112:115]
    s_waitcnt lgkmcnt(6)
    v_mfma_f32_16x16x32_bf16 v[112:115], v[76:79], v[52:55], v[112:115]
    v_mfma_f32_16x16x32_bf16 v[116:119], v[68:71], v[56:59], 0
    v_mul_f32 v92, s49, v92
    v_mul_f32 v93, s49, v93
    v_mfma_f32_16x16x32_bf16 v[116:119], v[72:75], v[60:63], v[116:119]
    v_mul_f32 v94, s49, v94
    v_mul_f32 v95, s49, v95
    v_mfma_f32_16x16x32_bf16 v[116:119], v[76:79], v[64:67], v[116:119]
    v_cvt_pk_bf16_f32 v92, v92, v93
    v_cvt_pk_bf16_f32 v93, v94, v95
    s_waitcnt lgkmcnt(5)
    v_mfma_f32_16x16x32_bf16 v[120:123], v[32:35], v[80:83], 0
    ds_write_b64 v17, v[92:93] offset:0
    s_waitcnt lgkmcnt(5)
    v_mfma_f32_16x16x32_bf16 v[120:123], v[36:39], v[84:87], v[120:123]
    v_mul_f32 v108, s49, v108
    v_mul_f32 v109, s49, v109
    s_waitcnt lgkmcnt(4)
    v_mfma_f32_16x16x32_bf16 v[120:123], v[40:43], v[88:91], v[120:123]
    v_mul_f32 v110, s49, v110
    v_mul_f32 v111, s49, v111
    v_mfma_f32_16x16x32_bf16 v[124:127], v[68:71], v[80:83], 0
    v_cvt_pk_bf16_f32 v108, v108, v109
    v_cvt_pk_bf16_f32 v109, v110, v111
    v_mfma_f32_16x16x32_bf16 v[124:127], v[72:75], v[84:87], v[124:127]
    v_mul_f32 v112, s49, v112
    v_mul_f32 v113, s49, v113
    v_mfma_f32_16x16x32_bf16 v[124:127], v[76:79], v[88:91], v[124:127]
    ds_write_b64 v17, v[108:109] offset:6144
    s_waitcnt lgkmcnt(4)
    v_mfma_f32_16x16x32_bf16 v[128:131], v[96:99], v[44:47], 0
    v_mul_f32 v114, s49, v114
    v_mul_f32 v115, s49, v115
    s_waitcnt lgkmcnt(3)
    v_mfma_f32_16x16x32_bf16 v[128:131], v[100:103], v[48:51], v[128:131]
    v_cvt_pk_bf16_f32 v112, v112, v113
    v_cvt_pk_bf16_f32 v113, v114, v115
    s_waitcnt lgkmcnt(2)
    v_mfma_f32_16x16x32_bf16 v[128:131], v[104:107], v[52:55], v[128:131]
    ds_write_b64 v17, v[112:113] offset:1024
    v_mfma_f32_16x16x32_bf16 v[132:135], v[96:99], v[56:59], 0
    v_mul_f32 v116, s49, v116
    v_mul_f32 v117, s49, v117
    v_mfma_f32_16x16x32_bf16 v[132:135], v[100:103], v[60:63], v[132:135]
    v_mul_f32 v118, s49, v118
    v_mul_f32 v119, s49, v119
    v_mfma_f32_16x16x32_bf16 v[132:135], v[104:107], v[64:67], v[132:135]
    v_cvt_pk_bf16_f32 v116, v116, v117
    v_cvt_pk_bf16_f32 v117, v118, v119
    v_mfma_f32_16x16x32_bf16 v[136:139], v[96:99], v[80:83], 0
    ds_write_b64 v17, v[116:117] offset:7168
    v_mfma_f32_16x16x32_bf16 v[136:139], v[100:103], v[84:87], v[136:139]
    v_mul_f32 v120, s49, v120
    v_mul_f32 v121, s49, v121
    v_mfma_f32_16x16x32_bf16 v[136:139], v[104:107], v[88:91], v[136:139]
    v_mul_f32 v122, s49, v122
    v_mul_f32 v123, s49, v123
    v_cvt_pk_bf16_f32 v120, v120, v121
    v_cvt_pk_bf16_f32 v121, v122, v123
    ds_write_b64 v17, v[120:121] offset:12288
    v_mul_f32 v124, s49, v124
    v_mul_f32 v125, s49, v125
    v_mul_f32 v126, s49, v126
    v_mul_f32 v127, s49, v127
    v_cvt_pk_bf16_f32 v124, v124, v125
    v_cvt_pk_bf16_f32 v125, v126, v127
    ds_write_b64 v17, v[124:125] offset:13312
    v_mul_f32 v128, s49, v128
    v_mul_f32 v129, s49, v129
    v_mul_f32 v130, s49, v130
    v_mul_f32 v131, s49, v131
    v_cvt_pk_bf16_f32 v128, v128, v129
    v_cvt_pk_bf16_f32 v129, v130, v131
    ds_write_b64 v17, v[128:129] offset:2048
    v_mul_f32 v132, s49, v132
    v_mul_f32 v133, s49, v133
    v_mul_f32 v136, s49, v136
    v_mul_f32 v137, s49, v137
    v_mul_f32 v134, s49, v134
L_h0:
    s_cbranch_execz L_h2
    v_mul_f32 v135, s49, v135
    v_cvt_pk_bf16_f32 v132, v132, v133
    v_mul_f32 v138, s49, v138
    v_mul_f32 v139, s49, v139
    v_cvt_pk_bf16_f32 v136, v136, v137
    v_cvt_pk_bf16_f32 v133, v134, v135
    v_cvt_pk_bf16_f32 v137, v138, v139
    ds_write_b64 v17, v[132:133] offset:8192
    ds_write_b64 v17, v[136:137] offset:14336
    s_waitcnt lgkmcnt(0)
    s_barrier
    ds_read_b128 a[0:3], v243 offset:0
    ds_read_b128 a[4:7], v243 offset:1024
    ds_read_b128 a[8:11], v243 offset:2048
    ds_read_b128 a[12:15], v243 offset:3072
    ds_read_b128 a[16:19], v243 offset:4096
    ds_read_b128 a[20:23], v243 offset:5120
    ds_read_b128 a[24:27], v243 offset:6144
    ds_read_b128 a[28:31], v243 offset:7168
    ds_read_b128 a[32:35], v243 offset:8192
    ds_read_b128 a[36:39], v243 offset:9216
    ds_read_b128 a[40:43], v243 offset:10240
    ds_read_b128 a[44:47], v243 offset:11264
    ds_read_b128 a[48:51], v243 offset:12288
    ds_read_b128 a[52:55], v243 offset:13312
    ds_read_b128 a[56:59], v243 offset:14336
    ds_read_b128 a[60:63], v243 offset:15360
    ds_read_b128 a[64:67], v243 offset:16384
    ds_read_b128 a[68:71], v243 offset:17408
    s_add_u32 m0, s60, 36864
    s_add_u32 s41, s37, 9144576
    buffer_load_dwordx4 v4, s[12:15], s41 offen offset:0 nt lds
    s_add_u32 m0, s60, 36864
    s_add_u32 s41, s37, 9144576
    buffer_load_dwordx4 v5, s[12:15], s41 offen offset:1024 nt lds
    s_add_u32 m0, s60, 36864
    s_add_u32 s41, s37, 9215808
    buffer_load_dwordx4 v6, s[12:15], s41 offen offset:2048 nt lds
    s_waitcnt vmcnt(9) lgkmcnt(0)
L_main:
    ds_read_b128 v[16:19], v2 offset:0
    ds_read_b128 v[20:23], v2 offset:64
    ds_read_b128 v[24:27], v2 offset:128
    ds_read_b128 a[72:75], v246 offset:0
    ds_read_b128 a[76:79], v246 offset:1024
    ds_read_b128 a[80:83], v246 offset:2048
    ds_read_b128 a[84:87], v246 offset:3072
    ds_read_b128 a[88:91], v246 offset:4096
    ds_read_b128 a[92:95], v246 offset:5120
    ds_read_b64_tr_b16 a[96:97], v247 offset:0
    ds_read_b64_tr_b16 a[98:99], v247 offset:3072
    ds_read_b64_tr_b16 a[100:101], v247 offset:6144
    ds_read_b64_tr_b16 a[102:103], v247 offset:9216
    s_waitcnt lgkmcnt(12)
    v_mfma_f32_16x16x32_bf16 v[28:31], a[0:3], v[16:19], 0
    s_waitcnt lgkmcnt(11)
    ds_read_b64_tr_b16 a[104:105], v247 offset:12288
    v_mfma_f32_16x16x32_bf16 v[28:31], a[4:7], v[20:23], v[28:31]
    s_waitcnt lgkmcnt(10)
    ds_read_b64_tr_b16 a[106:107], v247 offset:15360
    v_mfma_f32_16x16x32_bf16 v[28:31], a[8:11], v[24:27], v[28:31]
    ds_read_b64_tr_b16 a[108:109], v247 offset:8
    v_bfe_u32 v203, v0, 2, 2
    v_mfma_f32_16x16x32_bf16 v[32:35], a[12:15], v[16:19], 0
    s_barrier
    v_mfma_f32_16x16x32_bf16 v[32:35], a[16:19], v[20:23], v[32:35]
    s_add_u32 m0, s29, 0
    ds_read_b128 a[112:115], v244 offset:0
    v_mfma_f32_16x16x32_bf16 v[32:35], a[20:23], v[24:27], v[32:35]
    buffer_load_dwordx4 v240, s[24:27], s3 offen offset:0 lds
    v_mfma_f32_16x16x32_bf16 v[36:39], a[24:27], v[16:19], 0
    ds_read_b128 a[116:119], v244 offset:64
    v_cvt_pk_bf16_f32 v40, v28, v29
    v_mfma_f32_16x16x32_bf16 v[36:39], a[28:31], v[20:23], v[36:39]
    ds_read_b128 a[120:123], v244 offset:128
    v_cvt_pk_bf16_f32 v41, v30, v31
    v_mfma_f32_16x16x32_bf16 v[36:39], a[32:35], v[24:27], v[36:39]
    s_add_u32 m0, s29, 0
    v_cvt_pk_bf16_f32 v42, v32, v33
    v_cvt_pk_bf16_f32 v43, v34, v35
    v_mfma_f32_16x16x32_bf16 v[44:47], a[36:39], v[16:19], 0
    buffer_load_dwordx4 v241, s[24:27], s3 offen offset:1024 lds
    v_mfma_f32_16x16x32_bf16 v[44:47], a[40:43], v[20:23], v[44:47]
    ds_read_b64_tr_b16 a[110:111], v247 offset:3080
    v_min_u32 v203, 2, v203
    v_mfma_f32_16x16x32_bf16 v[44:47], a[44:47], v[24:27], v[44:47]
    ds_read_b64_tr_b16 a[124:125], v247 offset:6152
    v_cvt_pk_bf16_f32 v48, v36, v37
    v_mfma_f32_16x16x32_bf16 v[52:55], a[48:51], v[16:19], 0
    s_add_u32 m0, s29, 0
    ds_read_b64_tr_b16 a[126:127], v247 offset:9224
    v_mfma_f32_16x16x32_bf16 v[52:55], a[52:55], v[20:23], v[52:55]
    buffer_load_dwordx4 v242, s[24:27], s3 offen offset:2048 lds
    v_mfma_f32_16x16x32_bf16 v[52:55], a[56:59], v[24:27], v[52:55]
    ds_read_b64_tr_b16 a[128:129], v247 offset:12296
    v_cvt_pk_bf16_f32 v49, v38, v39
    v_mfma_f32_16x16x32_bf16 v[56:59], a[60:63], v[16:19], 0
    ds_read_b64_tr_b16 a[130:131], v247 offset:15368
    v_cvt_pk_bf16_f32 v50, v44, v45
    v_mfma_f32_16x16x32_bf16 v[56:59], a[64:67], v[20:23], v[56:59]
    s_waitcnt lgkmcnt(4)
    s_add_u32 m0, s60, 36864
    s_add_u32 s41, s37, 9287040
    v_mfma_f32_16x16x32_bf16 v[56:59], a[68:71], v[24:27], v[56:59]
    buffer_load_dwordx4 v7, s[12:15], s41 offen offset:3072 nt lds
    v_mfma_f32_16x16x32_bf16 v[60:63], a[72:75], a[112:115], 0
    s_mov_b32 s62, 571524
    v_cvt_pk_bf16_f32 v51, v46, v47
    v_cvt_pk_bf16_f32 v64, v52, v53
    v_mfma_f32_16x16x32_bf16 v[60:63], a[76:79], a[116:119], v[60:63]
    ds_read_b128 a[132:135], v245 offset:0
    v_cvt_pk_bf16_f32 v65, v54, v55
    v_mfma_f32_16x16x32_bf16 v[60:63], a[80:83], a[120:123], v[60:63]
    s_mov_b32 s94, 0x22222222
    v_cvt_pk_bf16_f32 v66, v56, v57
    v_cvt_pk_bf16_f32 v67, v58, v59
    v_mfma_f32_16x16x32_bf16 v[68:71], a[84:87], a[112:115], 0
    s_waitcnt vmcnt(10)
    ds_read_b128 v[72:75], v2 offset:3072
    v_mfma_f32_16x16x32_bf16 v[68:71], a[88:91], a[116:119], v[68:71]
    ds_read_b128 v[76:79], v2 offset:3136
    v_and_b32 v13, 48, v0
    v_mfma_f32_16x16x32_bf16 v[68:71], a[92:95], a[120:123], v[68:71]
    ds_read_b128 v[80:83], v2 offset:3200
    v_mul_u32_u24 v203, 2880, v203
    v_mfma_f32_16x16x32_bf16 v[84:87], a[96:99], a[112:115], 0
    s_mov_b32 s95, 0x22222222
    v_cvt_pk_bf16_f32 v88, v60, v61
    v_cvt_pk_bf16_f32 v89, v62, v63
    v_mfma_f32_16x16x32_bf16 v[84:87], a[100:103], a[116:119], v[84:87]
    s_lshl_b64 s[96:97], s[94:95], 1
    v_add3_u32 v14, v13, v203, s38
    v_mad_u32_u24 v15, v13, s62, v178
    v_mfma_f32_16x16x32_bf16 v[84:87], a[104:107], a[120:123], v[84:87]
    s_waitcnt lgkmcnt(3)
    v_cvt_pk_bf16_f32 v90, v68, v69
    v_cvt_pk_bf16_f32 v91, v70, v71
    v_mfma_f32_16x16x32_bf16 v[92:95], a[108:111], a[112:115], 0
    s_lshl_b64 s[98:99], s[94:95], 2
    v_and_b32 v199, 1, v199
    v_lshlrev_b32 v199, 5, v199
    v_mfma_f32_16x16x32_bf16 v[92:95], a[124:127], a[116:119], v[92:95]
    s_waitcnt lgkmcnt(2)
    s_add_u32 m0, s60, 40960
    s_add_u32 s41, s37, 9362368
    v_mfma_f32_16x16x32_bf16 v[92:95], a[128:131], a[120:123], v[92:95]
    s_waitcnt lgkmcnt(1)
    v_cvt_pk_bf16_f32 v96, v84, v85
    v_cvt_pk_bf16_f32 v97, v86, v87
    v_mfma_f32_16x16x32_bf16 v[100:103], a[0:3], v[72:75], 0
    s_waitcnt lgkmcnt(0)
    v_mad_u32_u24 v198, v198, s40, v199
    v_and_b32 v199, 3, v0
    v_mfma_f32_16x16x32_bf16 v[100:103], a[4:7], v[76:79], v[100:103]
    buffer_load_dwordx4 v8, s[12:15], s41 offen offset:0 nt lds
    v_mfma_f32_16x16x32_bf16 v[100:103], a[8:11], v[80:83], v[100:103]
    s_lshl_b32 s42, s45, 4
    v_cvt_pk_bf16_f32 v98, v92, v93
    v_cvt_pk_bf16_f32 v99, v94, v95
    v_mfma_f32_16x16x32_bf16 v[104:107], a[12:15], v[72:75], 0
    s_add_u32 s43, s47, 18432
    v_lshl_add_u32 v198, v199, 3, v198
    v_add_u32 v13, 18432, v198
    v_mfma_f32_16x16x32_bf16 v[104:107], a[16:19], v[76:79], v[104:107]
    s_movk_i32 s63, 3120
    v_cvt_pk_bf16_f32 v108, v100, v101
    v_cvt_pk_bf16_f32 v109, v102, v103
    v_mfma_f32_16x16x32_bf16 v[104:107], a[20:23], v[80:83], v[104:107]
    v_add_u32 v203, s42, v169
    v_mul_u32_u24 v198, 43, v203
    v_mfma_f32_16x16x32_bf16 v[112:115], a[24:27], v[72:75], 0
    s_add_u32 s42, s42, 32
    v_lshl_add_u32 v200, v164, 8, s43
    v_and_b32 v201, 8, v201
    v_mfma_f32_16x16x32_bf16 v[112:115], a[28:31], v[76:79], v[112:115]
    v_lshrrev_b32 v198, 8, v198
    v_cvt_pk_bf16_f32 v110, v104, v105
    v_mfma_f32_16x16x32_bf16 v[112:115], a[32:35], v[80:83], v[112:115]
    v_cvt_pk_bf16_f32 v111, v106, v107
    v_mad_u32_u24 v203, v203, s63, v200
    v_mfma_f32_16x16x32_bf16 v[116:119], a[36:39], v[72:75], 0
    v_xor_b32 v164, v201, v198
    v_lshl_add_u32 v203, v164, 4, v203
    v_mfma_f32_16x16x32_bf16 v[116:119], a[40:43], v[76:79], v[116:119]
    s_add_u32 m0, s60, 40960
    s_add_u32 s41, s37, 9362368
    v_cvt_pk_bf16_f32 v120, v112, v113
    v_mfma_f32_16x16x32_bf16 v[116:119], a[44:47], v[80:83], v[116:119]
    buffer_load_dwordx4 v9, s[12:15], s41 offen offset:1024 nt lds
    v_mfma_f32_16x16x32_bf16 v[124:127], a[48:51], v[72:75], 0
    v_cvt_pk_bf16_f32 v121, v114, v115
    v_mul_u32_u24 v198, 18720, v198
    v_mfma_f32_16x16x32_bf16 v[124:127], a[52:55], v[76:79], v[124:127]
    v_sub_u32 v164, v203, v198
    v_add_u32 v203, s42, v169
    v_mfma_f32_16x16x32_bf16 v[124:127], a[56:59], v[80:83], v[124:127]
    s_add_u32 s42, s42, 32
    v_cvt_pk_bf16_f32 v122, v116, v117
    v_cvt_pk_bf16_f32 v123, v118, v119
    v_mfma_f32_16x16x32_bf16 v[128:131], a[60:63], v[72:75], 0
    v_mul_u32_u24 v198, 43, v203
    v_lshrrev_b32 v198, 8, v198
    v_mfma_f32_16x16x32_bf16 v[128:131], a[64:67], v[76:79], v[128:131]
    s_waitcnt vmcnt(9)
    ds_read_b128 v[132:135], v2 offset:6144
    v_mfma_f32_16x16x32_bf16 v[128:131], a[68:71], v[80:83], v[128:131]
    ds_read_b128 v[136:139], v2 offset:6208
    v_cvt_pk_bf16_f32 v140, v124, v125
    v_mfma_f32_16x16x32_bf16 v[144:147], a[132:135], v[88:91], 0
    ds_read_b128 v[148:151], v2 offset:6272
    v_cvt_pk_bf16_f32 v141, v126, v127
    v_mfma_f32_16x16x32_bf16 v[152:155], v[16:19], v[40:43], 0
    v_mad_u32_u24 v203, v203, s63, v200
    v_xor_b32 v199, v201, v198
    v_mfma_f32_16x16x32_bf16 v[152:155], v[20:23], v[48:51], v[152:155]
    ds_write_b128 v248, v[88:91] offset:192
    v_mfma_f32_16x16x32_bf16 v[152:155], v[24:27], v[64:67], v[152:155]
    ds_write_b128 v248, v[96:99] offset:0
    v_mfma_f32_16x16x32_bf16 v[156:159], v[72:75], v[40:43], 0
    s_add_u32 m0, s29, 6144
    v_cndmask_b32 v144, v144, v145, s[94:95]
    v_cndmask_b32 v144, v144, v146, s[96:97]
    v_mfma_f32_16x16x32_bf16 v[156:159], v[76:79], v[48:51], v[156:159]
    s_waitcnt lgkmcnt(2)
    v_cndmask_b32 v144, v144, v147, s[98:99]
    v_cvt_pk_bf16_f32 v142, v128, v129
    v_mfma_f32_16x16x32_bf16 v[156:159], v[80:83], v[64:67], v[156:159]
    ds_write_b32 v249, v144
    v_mfma_f32_16x16x32_bf16 v[160:163], v[132:135], v[40:43], 0
    buffer_load_dwordx4 v240, s[24:27], s92 offen offset:0 lds
    v_mfma_f32_16x16x32_bf16 v[160:163], v[136:139], v[48:51], v[160:163]
    s_add_u32 m0, s29, 6144
    v_cvt_pk_bf16_f32 v143, v130, v131
    v_lshl_add_u32 v203, v199, 4, v203
    v_mfma_f32_16x16x32_bf16 v[160:163], v[148:151], v[64:67], v[160:163]
    buffer_load_dwordx4 v241, s[24:27], s92 offen offset:1024 lds
    v_mfma_f32_16x16x32_bf16 v[204:207], v[16:19], v[108:111], 0
    ds_read_b64_tr_b16 a[136:137], v165 offset:0
    v_mul_u32_u24 v198, 18720, v198
    v_mfma_f32_16x16x32_bf16 v[204:207], v[20:23], v[120:123], v[204:207]
    s_waitcnt lgkmcnt(1)
    s_barrier
    v_mfma_f32_16x16x32_bf16 v[204:207], v[24:27], v[140:143], v[204:207]
    s_add_u32 m0, s29, 6144
    ds_read_b64_tr_b16 a[138:139], v165 offset:3072
    v_mfma_f32_16x16x32_bf16 v[208:211], v[72:75], v[108:111], 0
    buffer_load_dwordx4 v242, s[24:27], s92 offen offset:2048 lds
    v_mfma_f32_16x16x32_bf16 v[208:211], v[76:79], v[120:123], v[208:211]
    ds_read_b64_tr_b16 a[140:141], v165 offset:6144
    v_sub_u32 v199, v203, v198
    v_mfma_f32_16x16x32_bf16 v[208:211], v[80:83], v[140:143], v[208:211]
    ds_read_b64_tr_b16 a[142:143], v167 offset:0
    v_add_u32 v198, s42, v169
    v_mfma_f32_16x16x32_bf16 v[212:215], v[132:135], v[108:111], 0
    s_add_u32 m0, s60, 40960
    s_add_u32 s41, s37, 9433600
    v_mul_u32_u24 v169, 43, v198
    v_mfma_f32_16x16x32_bf16 v[212:215], v[136:139], v[120:123], v[212:215]
    buffer_load_dwordx4 v10, s[12:15], s41 offen offset:2048 nt lds
    v_mfma_f32_16x16x32_bf16 v[212:215], v[148:151], v[140:143], v[212:215]
    ds_read_b64_tr_b16 a[144:145], v166 offset:0
    v_lshrrev_b32 v169, 8, v169
    v_mfma_f32_16x16x32_bf16 v[216:219], a[0:3], v[132:135], 0
    ds_read_b128 v[220:223], v168 offset:0
    v_mad_u32_u24 v198, v198, s63, v200
    v_mfma_f32_16x16x32_bf16 v[216:219], a[4:7], v[136:139], v[216:219]
    ds_read_b128 v[224:227], v168 offset:64
    v_xor_b32 v200, v201, v169
    v_mfma_f32_16x16x32_bf16 v[216:219], a[8:11], v[148:151], v[216:219]
    ds_read_b128 v[228:231], v168 offset:128
    v_lshl_add_u32 v198, v200, 4, v198
    v_mfma_f32_16x16x32_bf16 v[232:235], a[12:15], v[132:135], 0
    ds_read_b64_tr_b16 a[146:147], v166 offset:3072
    v_mul_u32_u24 v169, 18720, v169
    v_mfma_f32_16x16x32_bf16 v[232:235], a[16:19], v[136:139], v[232:235]
    ds_read_b64_tr_b16 a[148:149], v166 offset:6144
    v_sub_u32 v200, v198, v169
    v_mfma_f32_16x16x32_bf16 v[232:235], a[20:23], v[148:151], v[232:235]
    ds_read_b64_tr_b16 a[150:151], v167 offset:32
    v_cvt_pk_bf16_f32 v236, v216, v217
    v_mfma_f32_16x16x32_bf16 v[28:31], a[24:27], v[132:135], 0
    ds_read_b64_tr_b16 a[152:153], v165 offset:64
    v_cvt_pk_bf16_f32 v237, v218, v219
    v_mfma_f32_16x16x32_bf16 v[28:31], a[28:31], v[136:139], v[28:31]
    ds_read_b64_tr_b16 a[154:155], v165 offset:3136
    v_exp_f32 v152, v152
    v_mfma_f32_16x16x32_bf16 v[28:31], a[32:35], v[148:151], v[28:31]
    ds_read_b64_tr_b16 a[156:157], v165 offset:6208
    v_cvt_pk_bf16_f32 v238, v232, v233
    v_mfma_f32_16x16x32_bf16 v[32:35], a[36:39], v[132:135], 0
    s_add_u32 m0, s60, 40960
    s_add_u32 s41, s37, 9504832
    v_cvt_pk_bf16_f32 v239, v234, v235
    v_mfma_f32_16x16x32_bf16 v[32:35], a[40:43], v[136:139], v[32:35]
    buffer_load_dwordx4 v11, s[12:15], s41 offen offset:3072 nt lds
    v_mfma_f32_16x16x32_bf16 v[32:35], a[44:47], v[148:151], v[32:35]
    ds_read_b64_tr_b16 a[158:159], v167 offset:64
    v_cvt_pk_bf16_f32 v36, v28, v29
    v_mfma_f32_16x16x32_bf16 v[44:47], a[48:51], v[132:135], 0
    ds_read_b64_tr_b16 a[160:161], v166 offset:64
    v_cvt_pk_bf16_f32 v37, v30, v31
    v_mfma_f32_16x16x32_bf16 v[44:47], a[52:55], v[136:139], v[44:47]
    ds_read_b64_tr_b16 a[162:163], v166 offset:3136
    v_exp_f32 v153, v153
    v_mfma_f32_16x16x32_bf16 v[44:47], a[56:59], v[148:151], v[44:47]
    ds_read_b64_tr_b16 a[164:165], v166 offset:6208
    v_cvt_pk_bf16_f32 v38, v32, v33
    v_mfma_f32_16x16x32_bf16 v[52:55], a[60:63], v[132:135], 0
    ds_read_b64_tr_b16 a[166:167], v167 offset:96
    v_cvt_pk_bf16_f32 v39, v34, v35
    v_mfma_f32_16x16x32_bf16 v[52:55], a[64:67], v[136:139], v[52:55]
    s_waitcnt lgkmcnt(5)
    v_exp_f32 v154, v154
    v_mfma_f32_16x16x32_bf16 v[52:55], a[68:71], v[148:151], v[52:55]
    ds_read_b64_tr_b16 a[168:169], v165 offset:128
    v_cvt_pk_bf16_f32 v56, v44, v45
    v_mfma_f32_16x16x32_bf16 v[60:63], v[220:223], v[16:19], 0
    ds_read_b64_tr_b16 a[170:171], v165 offset:3200
    v_cvt_pk_bf16_f32 v57, v46, v47
    v_mfma_f32_16x16x32_bf16 v[60:63], v[224:227], v[20:23], v[60:63]
    ds_read_b64_tr_b16 a[172:173], v165 offset:6272
    v_cvt_pk_bf16_f32 v68, v152, v153
    v_mfma_f32_16x16x32_bf16 v[60:63], v[228:231], v[24:27], v[60:63]
    ds_read_b64_tr_b16 a[174:175], v167 offset:128
    v_cvt_pk_bf16_f32 v58, v52, v53
    v_mfma_f32_16x16x32_bf16 v[84:87], v[220:223], v[72:75], 0
    s_add_u32 m0, s60, 45056
    s_add_u32 s41, s37, 9580160
    v_cvt_pk_bf16_f32 v59, v54, v55
    v_mfma_f32_16x16x32_bf16 v[84:87], v[224:227], v[76:79], v[84:87]
    buffer_load_dwordx4 v12, s[12:15], s41 offen offset:0 nt lds
    v_mfma_f32_16x16x32_bf16 v[84:87], v[228:231], v[80:83], v[84:87]
    ds_read_b128 v[92:95], v170 offset:704
    v_cndmask_b32 v169, v177, v60, s[50:51]
    v_mfma_f32_16x16x32_bf16 v[100:103], v[220:223], v[132:135], 0
    ds_read_b64_tr_b16 a[176:177], v166 offset:128
    v_exp_f32 v155, v155
    v_mfma_f32_16x16x32_bf16 v[100:103], v[224:227], v[136:139], v[100:103]
    ds_read_b64_tr_b16 a[178:179], v166 offset:3200
    v_cvt_pk_bf16_f32 v69, v154, v155
    v_mfma_f32_16x16x32_bf16 v[100:103], v[228:231], v[148:151], v[100:103]
    ds_read_b64_tr_b16 a[180:181], v166 offset:6272
    v_cndmask_b32 v198, v177, v84, s[50:51]
    v_mfma_f32_16x16x32_bf16 v[104:107], v[16:19], v[236:239], 0
    ds_read_b64_tr_b16 a[182:183], v167 offset:160
    v_exp_f32 v156, v156
    v_mfma_f32_16x16x32_bf16 v[104:107], v[20:23], v[36:39], v[104:107]
    v_exp_f32 v157, v157
    v_mfma_f32_16x16x32_bf16 v[104:107], v[24:27], v[56:59], v[104:107]
    v_exp_f32 v158, v158
    v_mfma_f32_16x16x32_bf16 v[112:115], v[72:75], v[236:239], 0
    v_exp_f32 v159, v159
    v_mfma_f32_16x16x32_bf16 v[112:115], v[76:79], v[36:39], v[112:115]
    v_cvt_pk_bf16_f32 v70, v156, v157
    v_cvt_pk_bf16_f32 v71, v158, v159
    v_mfma_f32_16x16x32_bf16 v[112:115], v[80:83], v[56:59], v[112:115]
    v_exp_f32 v160, v160
    v_mfma_f32_16x16x32_bf16 v[116:119], v[132:135], v[236:239], 0
    s_add_u32 m0, s29, 12288
    v_exp_f32 v161, v161
    v_mfma_f32_16x16x32_bf16 v[116:119], v[136:139], v[36:39], v[116:119]
    buffer_load_dwordx4 v240, s[24:27], s93 offen offset:0 lds
    v_mfma_f32_16x16x32_bf16 v[116:119], v[148:151], v[56:59], v[116:119]
    v_exp_f32 v162, v162
    v_mfma_f32_16x16x32_bf16 v[124:127], v[180:183], v[68:71], 0
    v_exp_f32 v163, v163
    v_exp_f32 v169, v169
    v_cvt_pk_bf16_f32 v184, v160, v161
    v_cvt_pk_bf16_f32 v185, v162, v163
    v_cvt_pk_bf16_f32 v186, v169, 0
    s_waitcnt lgkmcnt(0)
    v_add_f32 v92, v92, v93
    v_mfma_f32_16x16x32_bf16 v[124:127], v[180:183], v[184:187], v[124:127]
    s_add_u32 m0, s29, 12288
    v_add_f32 v92, v92, v94
    v_cndmask_b32 v169, v177, v92, s[56:57]
    v_mfma_f32_16x16x32_bf16 v[88:91], a[136:139], v[68:71], 0
    buffer_load_dwordx4 v241, s[24:27], s93 offen offset:1024 lds
    v_mfma_f32_16x16x32_bf16 v[88:91], a[140:143], v[184:187], v[88:91]
    v_cndmask_b32 v169, v169, v61, s[50:51]
    v_cndmask_b32 v169, v169, v85, s[52:53]
    v_mfma_f32_16x16x32_bf16 v[96:99], a[144:147], v[68:71], 0
    v_cndmask_b32 v169, v169, v101, s[54:55]
    v_cndmask_b32 v201, v177, v100, s[50:51]
    v_mfma_f32_16x16x32_bf16 v[96:99], a[148:151], v[184:187], v[96:99]
    s_add_u32 m0, s29, 12288
    v_exp_f32 v169, v169
    v_mfma_f32_16x16x32_bf16 v[144:147], a[152:155], v[68:71], 0
    buffer_load_dwordx4 v242, s[24:27], s93 offen offset:2048 lds
    v_mfma_f32_16x16x32_bf16 v[144:147], a[156:159], v[184:187], v[144:147]
    v_cvt_pk_bf16_f32 v169, v169, v169
    v_exp_f32 v204, v204
    v_mfma_f32_16x16x32_bf16 v[128:131], a[160:163], v[68:71], 0
    ds_write_b16 v171, v169 offset:576
    v_mfma_f32_16x16x32_bf16 v[128:131], a[164:167], v[184:187], v[128:131]
    ds_read2_b64 v[40:43], v172 offset0:72 offset1:76
    s_add_u32 m0, s60, 73728
    v_mfma_f32_16x16x32_bf16 v[48:51], a[168:171], v[68:71], 0
    ds_read2_b64 v[64:67], v172 offset0:80 offset1:84
    s_add_u32 s41, s37, 18289152
    v_mfma_f32_16x16x32_bf16 v[48:51], a[172:175], v[184:187], v[48:51]
    buffer_load_dwordx4 v4, s[12:15], s41 offen offset:0 nt lds
    v_mfma_f32_16x16x32_bf16 v[108:111], a[176:179], v[68:71], 0
    v_exp_f32 v205, v205
    v_mfma_f32_16x16x32_bf16 v[108:111], a[180:183], v[184:187], v[108:111]
    v_exp_f32 v206, v206
    v_exp_f32 v207, v207
    v_exp_f32 v208, v208
    s_waitcnt lgkmcnt(1)
    v_mfma_f32_16x16x32_bf16 v[120:123], v[40:43], v[180:183], 0
    s_waitcnt lgkmcnt(0)
    v_exp_f32 v209, v209
    v_mfma_f32_16x16x32_bf16 v[120:123], v[64:67], v[180:183], v[120:123]
    v_exp_f32 v210, v210
    v_mfma_f32_16x16x32_bf16 v[140:143], v[40:43], a[136:139], 0
    v_exp_f32 v211, v211
    v_mfma_f32_16x16x32_bf16 v[140:143], v[64:67], a[140:143], v[140:143]
    v_cvt_pk_bf16_f32 v216, v204, v205
    v_cvt_pk_bf16_f32 v217, v206, v207
    v_mfma_f32_16x16x32_bf16 v[232:235], v[40:43], a[144:147], 0
    v_cvt_pk_bf16_f32 v218, v208, v209
    v_cvt_pk_bf16_f32 v219, v210, v211
    v_mfma_f32_16x16x32_bf16 v[232:235], v[64:67], a[148:151], v[232:235]
    v_exp_f32 v212, v212
    v_mfma_f32_16x16x32_bf16 v[28:31], v[40:43], a[152:155], 0
    v_exp_f32 v213, v213
    v_mfma_f32_16x16x32_bf16 v[28:31], v[64:67], a[156:159], v[28:31]
    v_exp_f32 v214, v214
    v_mfma_f32_16x16x32_bf16 v[32:35], v[40:43], a[160:163], 0
    v_exp_f32 v215, v215
    v_mfma_f32_16x16x32_bf16 v[32:35], v[64:67], a[164:167], v[32:35]
    s_add_u32 s41, s37, 18289152
    v_exp_f32 v198, v198
    v_mfma_f32_16x16x32_bf16 v[44:47], v[40:43], a[168:171], 0
    buffer_load_dwordx4 v5, s[12:15], s41 offen offset:1024 nt lds
    v_mfma_f32_16x16x32_bf16 v[44:47], v[64:67], a[172:175], v[44:47]
    v_cvt_pk_bf16_f32 v188, v212, v213
    v_cvt_pk_bf16_f32 v189, v214, v215
    v_mfma_f32_16x16x32_bf16 v[52:55], v[40:43], a[176:179], 0
    v_cvt_pk_bf16_f32 v190, v198, 0
    v_mov_b32 v169, v120
    v_mfma_f32_16x16x32_bf16 v[52:55], v[64:67], a[180:183], v[52:55]
    v_cvt_pk_bf16_f32 v198, v140, v232
    v_cvt_pk_bf16_f32 v203, v28, v32
    v_mfma_f32_16x16x32_bf16 v[152:155], v[180:183], v[216:219], 0
    ds_write_b32 v173, v198 offset:384
    v_mfma_f32_16x16x32_bf16 v[152:155], v[180:183], v[188:191], v[152:155]
    ds_write_b32 v173, v203 offset:448
    v_mfma_f32_16x16x32_bf16 v[220:223], a[136:139], v[216:219], 0
    v_exp_f32 v104, v104
    v_mfma_f32_16x16x32_bf16 v[220:223], a[140:143], v[188:191], v[220:223]
    v_exp_f32 v105, v105
    v_mfma_f32_16x16x32_bf16 v[224:227], a[144:147], v[216:219], 0
    v_exp_f32 v106, v106
    v_mfma_f32_16x16x32_bf16 v[224:227], a[148:151], v[188:191], v[224:227]
    v_exp_f32 v107, v107
    v_mfma_f32_16x16x32_bf16 v[228:231], a[152:155], v[216:219], 0
    v_exp_f32 v112, v112
    v_mfma_f32_16x16x32_bf16 v[228:231], a[156:159], v[188:191], v[228:231]
    v_exp_f32 v113, v113
    v_mfma_f32_16x16x32_bf16 v[16:19], a[160:163], v[216:219], 0
    v_exp_f32 v114, v114
    v_mfma_f32_16x16x32_bf16 v[16:19], a[164:167], v[188:191], v[16:19]
    s_add_u32 s41, s37, 18360384
    v_exp_f32 v115, v115
    v_mfma_f32_16x16x32_bf16 v[20:23], a[168:171], v[216:219], 0
    buffer_load_dwordx4 v6, s[12:15], s41 offen offset:2048 nt lds
    v_mfma_f32_16x16x32_bf16 v[20:23], a[172:175], v[188:191], v[20:23]
    v_cvt_pk_bf16_f32 v24, v104, v105
    v_cvt_pk_bf16_f32 v25, v106, v107
    v_mfma_f32_16x16x32_bf16 v[156:159], a[176:179], v[216:219], 0
    v_cvt_pk_bf16_f32 v26, v112, v113
    v_cvt_pk_bf16_f32 v27, v114, v115
    v_mfma_f32_16x16x32_bf16 v[156:159], a[180:183], v[188:191], v[156:159]
    v_exp_f32 v116, v116
    v_mfma_f32_16x16x32_bf16 v[72:75], v[180:183], v[24:27], 0
    v_exp_f32 v117, v117
    v_exp_f32 v118, v118
    v_exp_f32 v119, v119
    v_exp_f32 v201, v201
    v_cvt_pk_bf16_f32 v198, v44, v52
    v_cvt_pk_bf16_f32 v192, v116, v117
    v_cvt_pk_bf16_f32 v193, v118, v119
    v_cvt_pk_bf16_f32 v194, v201, 0
    ds_write_b32 v173, v198 offset:512
    v_rcp_f32 v198, v124
    v_mfma_f32_16x16x32_bf16 v[72:75], v[180:183], v[192:195], v[72:75]
    s_waitcnt vmcnt(6)
    ds_read_b128 v[76:79], v2 offset:36864
    v_mfma_f32_16x16x32_bf16 v[80:83], a[136:139], v[24:27], 0
    ds_read_b128 v[132:135], v2 offset:36928
    v_mul_f32 v88, v88, v198
    v_mfma_f32_16x16x32_bf16 v[80:83], a[140:143], v[192:195], v[80:83]
    ds_read_b128 v[236:239], v2 offset:36992
    v_mul_f32 v96, v96, v198
    v_mfma_f32_16x16x32_bf16 v[36:39], a[144:147], v[24:27], 0
    v_rcp_f32 v201, v152
    v_mfma_f32_16x16x32_bf16 v[36:39], a[148:151], v[192:195], v[36:39]
    v_rcp_f32 v203, v72
    v_mfma_f32_16x16x32_bf16 v[136:139], a[152:155], v[24:27], 0
    v_max3_u32 v28, v198, v201, v203
    v_cmp_lt_u32 vcc, 0x4b800000, v28
    v_mfma_f32_16x16x32_bf16 v[136:139], a[156:159], v[192:195], v[136:139]
    v_min3_u32 v28, v198, v201, v203
    s_mov_b64 s[58:59], vcc
    v_mfma_f32_16x16x32_bf16 v[56:59], a[160:163], v[24:27], 0
    v_cmp_gt_u32 vcc, 0x27800000, v28
    v_mul_f32 v89, v89, v198
    v_mfma_f32_16x16x32_bf16 v[56:59], a[164:167], v[192:195], v[56:59]
    s_add_u32 s41, s37, 18431616
    s_or_b64 s[58:59], s[58:59], vcc
    v_mul_f32 v97, v97, v198
    v_mfma_f32_16x16x32_bf16 v[148:151], a[168:171], v[24:27], 0
    buffer_load_dwordx4 v7, s[12:15], s41 offen offset:3072 nt lds
    v_mfma_f32_16x16x32_bf16 v[148:151], a[172:175], v[192:195], v[148:151]
    s_waitcnt vmcnt(4)
    v_mul_f32 v90, v90, v198
    v_mul_f32 v98, v98, v198
    v_mfma_f32_16x16x32_bf16 v[160:163], a[176:179], v[24:27], 0
    s_waitcnt lgkmcnt(0)
    v_mul_f32 v91, v91, v198
    v_mul_f32 v99, v99, v198
    v_mfma_f32_16x16x32_bf16 v[160:163], a[180:183], v[192:195], v[160:163]
    s_barrier
    v_mfma_f32_16x16x32_bf16 v[92:95], a[0:3], v[76:79], 0
    ds_read_b128 a[184:187], v202 offset:0
    v_cvt_pk_bf16_f32 v60, v88, v96
    v_mfma_f32_16x16x32_bf16 v[92:95], a[4:7], v[132:135], v[92:95]
    ds_read_b128 a[188:191], v202 offset:64
    v_cvt_pk_bf16_f32 v61, v89, v97
    v_mfma_f32_16x16x32_bf16 v[92:95], a[8:11], v[236:239], v[92:95]
    ds_read_b128 a[192:195], v202 offset:128
    v_cvt_pk_bf16_f32 v62, v90, v98
    v_mfma_f32_16x16x32_bf16 v[84:87], a[12:15], v[76:79], 0
    ds_read_b64_tr_b16 a[196:197], v13 offset:0
    v_cvt_pk_bf16_f32 v63, v91, v99
    v_mfma_f32_16x16x32_bf16 v[84:87], a[16:19], v[132:135], v[84:87]
    ds_read_b64_tr_b16 a[198:199], v13 offset:768
    v_mul_f32 v144, v144, v198
    v_mfma_f32_16x16x32_bf16 v[84:87], a[20:23], v[236:239], v[84:87]
    ds_read_b64_tr_b16 a[200:201], v13 offset:6144
    v_cvt_pk_bf16_f32 v100, v92, v93
    v_mfma_f32_16x16x32_bf16 v[68:71], a[24:27], v[76:79], 0
    ds_read_b64_tr_b16 a[202:203], v13 offset:6912
    v_cvt_pk_bf16_f32 v101, v94, v95
    v_mfma_f32_16x16x32_bf16 v[68:71], a[28:31], v[132:135], v[68:71]
    ds_read_b64_tr_b16 a[204:205], v13 offset:12288
    v_mul_f32 v128, v128, v198
    v_mfma_f32_16x16x32_bf16 v[68:71], a[32:35], v[236:239], v[68:71]
    ds_read_b64_tr_b16 a[206:207], v13 offset:13056
    v_cvt_pk_bf16_f32 v102, v84, v85
    v_mfma_f32_16x16x32_bf16 v[204:207], a[36:39], v[76:79], 0
    s_add_u32 m0, s60, 77824
    ds_read_b64_tr_b16 a[208:209], v13 offset:64
    v_mfma_f32_16x16x32_bf16 v[204:207], a[40:43], v[132:135], v[204:207]
    ds_read_b64_tr_b16 a[210:211], v13 offset:832
    s_add_u32 s41, s37, 18506944
    v_mfma_f32_16x16x32_bf16 v[204:207], a[44:47], v[236:239], v[204:207]
    ds_read_b64_tr_b16 a[212:213], v13 offset:6208
    v_cvt_pk_bf16_f32 v103, v86, v87
    v_mfma_f32_16x16x32_bf16 v[208:211], a[48:51], v[76:79], 0
    ds_read_b64_tr_b16 a[214:215], v13 offset:6976
    v_cvt_pk_bf16_f32 v212, v68, v69
    v_mfma_f32_16x16x32_bf16 v[208:211], a[52:55], v[132:135], v[208:211]
    ds_read_b64_tr_b16 a[216:217], v13 offset:12352
    v_cvt_pk_bf16_f32 v213, v70, v71
    v_mfma_f32_16x16x32_bf16 v[208:211], a[56:59], v[236:239], v[208:211]
    ds_read_b64_tr_b16 a[218:219], v13 offset:13120
    v_cvt_pk_bf16_f32 v214, v204, v205
    v_mfma_f32_16x16x32_bf16 v[120:123], a[60:63], v[76:79], 0
    ds_read_b128 a[220:223], v202 offset:6144
    v_cvt_pk_bf16_f32 v215, v206, v207
    v_mfma_f32_16x16x32_bf16 v[120:123], a[64:67], v[132:135], v[120:123]
L_h1:
    s_cbranch_execz L_h3
    s_waitcnt lgkmcnt(6)
    ds_read_b128 a[224:227], v202 offset:6208
    v_mfma_f32_16x16x32_bf16 v[120:123], a[68:71], v[236:239], v[120:123]
    ds_read_b128 a[228:231], v202 offset:6272
    v_cvt_pk_bf16_f32 v140, v208, v209
    v_mfma_f32_16x16x32_bf16 v[232:235], a[184:187], a[196:199], 0
    ds_read_b64_tr_b16 a[232:233], v13 offset:128
    v_cvt_pk_bf16_f32 v141, v210, v211
    v_mfma_f32_16x16x32_bf16 v[232:235], a[188:191], a[200:203], v[232:235]
    s_waitcnt lgkmcnt(6)
    ds_read_b64_tr_b16 a[234:235], v13 offset:896
    v_mfma_f32_16x16x32_bf16 v[232:235], a[192:195], a[204:207], v[232:235]
    ds_read_b64_tr_b16 a[236:237], v13 offset:6272
    v_cvt_pk_bf16_f32 v142, v120, v121
    v_mfma_f32_16x16x32_bf16 v[32:35], a[184:187], a[208:211], 0
    s_waitcnt lgkmcnt(6)
    ds_read_b64_tr_b16 a[238:239], v13 offset:7040
    v_mfma_f32_16x16x32_bf16 v[32:35], a[188:191], a[212:215], v[32:35]
    s_waitcnt lgkmcnt(6)
    ds_read_b64_tr_b16 a[240:241], v13 offset:12416
    v_mfma_f32_16x16x32_bf16 v[32:35], a[192:195], a[216:219], v[32:35]
    s_waitcnt lgkmcnt(6)
    ds_read_b64_tr_b16 a[242:243], v13 offset:13184
    v_mfma_f32_16x16x32_bf16 v[40:43], a[220:223], a[196:199], 0
    s_waitcnt lgkmcnt(6)
    ds_read_b128 a[244:247], v202 offset:12288
    v_mfma_f32_16x16x32_bf16 v[40:43], a[224:227], a[200:203], v[40:43]
    ds_read_b128 a[248:251], v202 offset:12352
    v_cvt_pk_bf16_f32 v232, v232, v233
    v_mfma_f32_16x16x32_bf16 v[40:43], a[228:231], a[204:207], v[40:43]
    ds_read_b128 a[252:255], v202 offset:12416
    v_cvt_pk_bf16_f32 v233, v234, v235
    v_mfma_f32_16x16x32_bf16 v[64:67], a[220:223], a[208:211], 0
    buffer_load_dwordx4 v8, s[12:15], s41 offen offset:0 nt lds
    v_mfma_f32_16x16x32_bf16 v[64:67], a[224:227], a[212:215], v[64:67]
    s_waitcnt lgkmcnt(4)
    s_add_u32 s41, s37, 18506944
    v_cvt_pk_bf16_f32 v32, v32, v33
    v_mfma_f32_16x16x32_bf16 v[64:67], a[228:231], a[216:219], v[64:67]
    buffer_load_dwordx4 v9, s[12:15], s41 offen offset:1024 nt lds
    v_mfma_f32_16x16x32_bf16 v[104:107], a[184:187], a[232:235], 0
    s_waitcnt lgkmcnt(1)
    v_cvt_pk_bf16_f32 v33, v34, v35
    v_cvt_pk_bf16_f32 v40, v40, v41
    v_mfma_f32_16x16x32_bf16 v[104:107], a[188:191], a[236:239], v[104:107]
    s_waitcnt lgkmcnt(0)
    s_barrier
    v_mfma_f32_16x16x32_bf16 v[104:107], a[192:195], a[240:243], v[104:107]
    ds_write_b64 v164, v[232:233] offset:0
    v_mfma_f32_16x16x32_bf16 v[112:115], a[220:223], a[232:235], 0
    ds_write_b64 v199, v[32:33] offset:0
    v_mfma_f32_16x16x32_bf16 v[112:115], a[224:227], a[236:239], v[112:115]
    ds_read_b128 v[216:219], v2 offset:39936
    v_cvt_pk_bf16_f32 v41, v42, v43
    v_mfma_f32_16x16x32_bf16 v[112:115], a[228:231], a[240:243], v[112:115]
    ds_write_b64 v164, v[40:41] offset:1024
    v_mfma_f32_16x16x32_bf16 v[44:47], a[244:247], a[196:199], 0
    ds_read_b128 v[52:55], v2 offset:40000
    v_cvt_pk_bf16_f32 v143, v122, v123
    v_mfma_f32_16x16x32_bf16 v[44:47], a[248:251], a[200:203], v[44:47]
    s_add_u32 s41, s37, 18578176
    v_cvt_pk_bf16_f32 v64, v64, v65
    v_cvt_pk_bf16_f32 v65, v66, v67
    v_mfma_f32_16x16x32_bf16 v[44:47], a[252:255], a[204:207], v[44:47]
    ds_write_b64 v199, v[64:65] offset:1024
    v_mfma_f32_16x16x32_bf16 v[116:119], a[244:247], a[208:211], 0
    buffer_load_dwordx4 v10, s[12:15], s41 offen offset:2048 nt lds
    v_mfma_f32_16x16x32_bf16 v[116:119], a[248:251], a[212:215], v[116:119]
    ds_read_b128 v[124:127], v2 offset:40064
    v_cvt_pk_bf16_f32 v104, v104, v105
    v_mfma_f32_16x16x32_bf16 v[116:119], a[252:255], a[216:219], v[116:119]
    ds_read_b128 v[152:155], v2 offset:43008
    v_cvt_pk_bf16_f32 v105, v106, v107
    v_mfma_f32_16x16x32_bf16 v[72:75], a[244:247], a[232:235], 0
    ds_write_b64 v200, v[104:105] offset:0
    v_mfma_f32_16x16x32_bf16 v[72:75], a[248:251], a[236:239], v[72:75]
    ds_read_b128 v[28:31], v2 offset:43072
    v_cvt_pk_bf16_f32 v112, v112, v113
    v_mfma_f32_16x16x32_bf16 v[72:75], a[252:255], a[240:243], v[72:75]
    ds_read_b128 v[24:27], v2 offset:43136
    v_cvt_pk_bf16_f32 v113, v114, v115
    v_mfma_f32_16x16x32_bf16 v[88:91], v[76:79], v[100:103], 0
    ds_write_b64 v200, v[112:113] offset:1024
    v_mfma_f32_16x16x32_bf16 v[88:91], v[132:135], v[212:215], v[88:91]
    s_waitcnt lgkmcnt(5)
    v_cvt_pk_bf16_f32 v44, v44, v45
    v_cvt_pk_bf16_f32 v116, v116, v117
    v_mfma_f32_16x16x32_bf16 v[88:91], v[236:239], v[140:143], v[88:91]
    v_cvt_pk_bf16_f32 v72, v72, v73
    v_cvt_pk_bf16_f32 v45, v46, v47
    v_mfma_f32_16x16x32_bf16 v[96:99], v[216:219], v[100:103], 0
    ds_write_b64 v164, v[44:45] offset:2048
    v_mfma_f32_16x16x32_bf16 v[96:99], v[52:55], v[212:215], v[96:99]
    s_waitcnt lgkmcnt(3)
    v_cvt_pk_bf16_f32 v117, v118, v119
    v_cvt_pk_bf16_f32 v73, v74, v75
    v_mfma_f32_16x16x32_bf16 v[96:99], v[124:127], v[140:143], v[96:99]
    ds_write_b64 v199, v[116:117] offset:2048
    v_mfma_f32_16x16x32_bf16 v[92:95], v[152:155], v[100:103], 0
    s_waitcnt lgkmcnt(2)
    s_add_u32 s41, s37, 18649408
    v_mul_f32 v145, v145, v198
    v_mfma_f32_16x16x32_bf16 v[92:95], v[28:31], v[212:215], v[92:95]
    ds_write_b64 v200, v[72:73] offset:2048
    v_mfma_f32_16x16x32_bf16 v[92:95], v[24:27], v[140:143], v[92:95]
    buffer_load_dwordx4 v11, s[12:15], s41 offen offset:3072 nt lds
    v_mfma_f32_16x16x32_bf16 v[84:87], a[0:3], v[216:219], 0
    ds_read_b128 v[68:71], v168 offset:2880
    v_mul_f32 v129, v129, v198
    v_mfma_f32_16x16x32_bf16 v[84:87], a[4:7], v[52:55], v[84:87]
    ds_read_b128 v[204:207], v168 offset:2944
    v_mul_f32 v146, v146, v198
    v_mfma_f32_16x16x32_bf16 v[84:87], a[8:11], v[124:127], v[84:87]
    ds_read_b128 v[208:211], v168 offset:3008
    v_mul_f32 v130, v130, v198
    v_mfma_f32_16x16x32_bf16 v[232:235], a[12:15], v[216:219], 0
    v_exp_f32 v92, v92
    v_mfma_f32_16x16x32_bf16 v[232:235], a[16:19], v[52:55], v[232:235]
    s_waitcnt lgkmcnt(3)
    s_barrier
    v_mfma_f32_16x16x32_bf16 v[232:235], a[20:23], v[124:127], v[232:235]
    ds_read_b128 a[72:75], v1 offset:18432
    v_cvt_pk_bf16_f32 v32, v84, v85
    v_mfma_f32_16x16x32_bf16 v[40:43], a[24:27], v[216:219], 0
    ds_read_b128 a[76:79], v1 offset:19456
    v_cvt_pk_bf16_f32 v33, v86, v87
    v_mfma_f32_16x16x32_bf16 v[40:43], a[28:31], v[52:55], v[40:43]
    ds_read_b128 a[80:83], v1 offset:20480
    v_mul_f32 v147, v147, v198
    v_mfma_f32_16x16x32_bf16 v[40:43], a[32:35], v[124:127], v[40:43]
    ds_read_b128 a[84:87], v1 offset:21552
    v_cvt_pk_bf16_f32 v34, v232, v233
    v_mfma_f32_16x16x32_bf16 v[120:123], a[36:39], v[216:219], 0
    ds_read_b128 a[88:91], v1 offset:22576
    v_cvt_pk_bf16_f32 v35, v234, v235
    v_mfma_f32_16x16x32_bf16 v[120:123], a[40:43], v[52:55], v[120:123]
    ds_read_b128 a[92:95], v1 offset:23600
    v_mul_f32 v131, v131, v198
    v_mfma_f32_16x16x32_bf16 v[120:123], a[44:47], v[124:127], v[120:123]
    s_add_u32 m0, s60, 81920
    v_exp_f32 v93, v93
    v_mfma_f32_16x16x32_bf16 v[64:67], a[48:51], v[216:219], 0
    s_add_u32 s41, s37, 18724736
    v_exp_f32 v94, v94
    v_mfma_f32_16x16x32_bf16 v[64:67], a[52:55], v[52:55], v[64:67]
    buffer_load_dwordx4 v12, s[12:15], s41 offen offset:0 nt lds
    v_mfma_f32_16x16x32_bf16 v[64:67], a[56:59], v[124:127], v[64:67]
    ds_read_b128 a[96:99], v1 offset:24672
    v_cvt_pk_bf16_f32 v184, v92, v93
    v_mfma_f32_16x16x32_bf16 v[104:107], a[60:63], v[216:219], 0
    ds_read_b128 a[100:103], v1 offset:25696
    v_cvt_pk_bf16_f32 v112, v40, v41
    v_mfma_f32_16x16x32_bf16 v[104:107], a[64:67], v[52:55], v[104:107]
    s_waitcnt lgkmcnt(2)
    v_exp_f32 v95, v95
    v_mfma_f32_16x16x32_bf16 v[104:107], a[68:71], v[124:127], v[104:107]
    ds_read_b128 a[104:107], v1 offset:26720
    v_cvt_pk_bf16_f32 v185, v94, v95
    v_mfma_f32_16x16x32_bf16 v[44:47], v[68:71], v[76:79], 0
    ds_read_b128 a[108:111], v1 offset:27792
    v_cvt_pk_bf16_f32 v113, v42, v43
    v_mfma_f32_16x16x32_bf16 v[44:47], v[204:207], v[132:135], v[44:47]
    ds_read_b128 a[112:115], v1 offset:28816
    v_cvt_pk_bf16_f32 v114, v120, v121
    v_mfma_f32_16x16x32_bf16 v[44:47], v[208:211], v[236:239], v[44:47]
    ds_read_b128 a[116:119], v1 offset:29840
    v_cvt_pk_bf16_f32 v115, v122, v123
    v_mfma_f32_16x16x32_bf16 v[116:119], v[68:71], v[216:219], 0
    ds_read_b128 a[124:127], v1 offset:30912
    v_cvt_pk_bf16_f32 v72, v64, v65
    v_mfma_f32_16x16x32_bf16 v[116:119], v[204:207], v[52:55], v[116:119]
    ds_read_b128 a[120:123], v1 offset:31936
    v_cvt_pk_bf16_f32 v73, v66, v67
    v_mfma_f32_16x16x32_bf16 v[116:119], v[208:211], v[124:127], v[116:119]
    ds_read_b128 a[128:131], v1 offset:32960
    v_cndmask_b32 v13, v177, v44, s[50:51]
    v_mfma_f32_16x16x32_bf16 v[100:103], v[68:71], v[152:155], 0
    ds_read_b128 a[132:135], v1 offset:34032
    v_cvt_pk_bf16_f32 v74, v104, v105
    v_mfma_f32_16x16x32_bf16 v[100:103], v[204:207], v[28:31], v[100:103]
    ds_read_b128 a[136:139], v1 offset:35056
    v_cvt_pk_bf16_f32 v75, v106, v107
    v_mfma_f32_16x16x32_bf16 v[100:103], v[208:211], v[24:27], v[100:103]
    ds_read_b128 a[140:143], v1 offset:36080
    v_cndmask_b32 v164, v177, v116, s[50:51]
    v_mfma_f32_16x16x32_bf16 v[212:215], v[76:79], v[32:35], 0
    ds_read_b64_tr_b16 a[144:145], v165 offset:36864
    v_cvt_pk_bf16_f32 v140, v144, v128
    v_mfma_f32_16x16x32_bf16 v[212:215], v[132:135], v[112:115], v[212:215]
    ds_read_b64_tr_b16 a[146:147], v165 offset:39936
    v_cvt_pk_bf16_f32 v141, v145, v129
    v_mfma_f32_16x16x32_bf16 v[212:215], v[236:239], v[72:75], v[212:215]
    ds_read_b64_tr_b16 a[148:149], v165 offset:43008
    v_cndmask_b32 v199, v177, v100, s[50:51]
    v_mfma_f32_16x16x32_bf16 v[84:87], v[216:219], v[32:35], 0
    ds_read_b64_tr_b16 a[150:151], v167 offset:192
    v_cvt_pk_bf16_f32 v142, v146, v130
    v_mfma_f32_16x16x32_bf16 v[84:87], v[52:55], v[112:115], v[84:87]
    ds_read_b64_tr_b16 a[152:153], v166 offset:36864
    v_cvt_pk_bf16_f32 v143, v147, v131
    v_mfma_f32_16x16x32_bf16 v[84:87], v[124:127], v[72:75], v[84:87]
    ds_read_b64_tr_b16 a[154:155], v166 offset:39936
    v_mul_f32 v48, v48, v198
    v_mfma_f32_16x16x32_bf16 v[232:235], v[152:155], v[32:35], 0
    ds_read_b64_tr_b16 a[156:157], v166 offset:43008
    v_mul_f32 v108, v108, v198
    v_mfma_f32_16x16x32_bf16 v[232:235], v[28:31], v[112:115], v[232:235]
    ds_read_b64_tr_b16 a[158:159], v167 offset:224
    v_mul_f32 v49, v49, v198
    v_mfma_f32_16x16x32_bf16 v[232:235], v[24:27], v[72:75], v[232:235]
    ds_read_b64_tr_b16 a[160:161], v165 offset:36928
    v_mul_f32 v109, v109, v198
    v_mfma_f32_16x16x32_bf16 v[92:95], v[60:63], a[72:75], 0
    ds_read_b64_tr_b16 a[162:163], v165 offset:40000
    v_mul_f32 v50, v50, v198
    v_mfma_f32_16x16x32_bf16 v[92:95], v[140:143], a[76:79], v[92:95]
    v_exp_f32 v13, v13
    v_exp_f32 v164, v164
    v_cvt_pk_bf16_f32 v186, v13, 0
    v_exp_f32 v232, v232
    v_exp_f32 v233, v233
    v_exp_f32 v234, v234
    v_exp_f32 v235, v235
    v_cvt_pk_bf16_f32 v188, v232, v233
    v_cvt_pk_bf16_f32 v189, v234, v235
    v_cvt_pk_bf16_f32 v190, v164, 0
    v_exp_f32 v199, v199
    v_mul_f32 v110, v110, v198
    v_cvt_pk_bf16_f32 v194, v199, 0
    v_mul_f32 v51, v51, v198
    v_mul_f32 v111, v111, v198
    v_cvt_pk_bf16_f32 v40, v48, v108
    v_cvt_pk_bf16_f32 v41, v49, v109
    v_cvt_pk_bf16_f32 v42, v50, v110
    v_cvt_pk_bf16_f32 v43, v51, v111
    v_exp_f32 v88, v88
    v_exp_f32 v89, v89
    v_mfma_f32_16x16x32_bf16 v[92:95], v[40:43], a[80:83], v[92:95]
    ds_read_b64_tr_b16 a[164:165], v165 offset:43072
    v_cvt_pk_bf16_f32 v120, v88, v89
    v_mfma_f32_16x16x32_bf16 v[64:67], v[60:63], a[84:87], 0
    ds_read_b64_tr_b16 a[166:167], v167 offset:256
    v_mul_f32 v220, v220, v201
    v_mfma_f32_16x16x32_bf16 v[64:67], v[140:143], a[88:91], v[64:67]
    s_waitcnt lgkmcnt(2)
    v_exp_f32 v90, v90
    v_mfma_f32_16x16x32_bf16 v[64:67], v[40:43], a[92:95], v[64:67]
    ds_read_b64_tr_b16 a[168:169], v166 offset:36928
    v_mul_f32 v224, v224, v201
    v_mfma_f32_16x16x32_bf16 v[104:107], v[60:63], a[96:99], 0
    ds_read_b64_tr_b16 a[170:171], v166 offset:40000
    v_mul_f32 v221, v221, v201
    v_mfma_f32_16x16x32_bf16 v[104:107], v[140:143], a[100:103], v[104:107]
    ds_read_b64_tr_b16 a[172:173], v166 offset:43072
    v_mul_f32 v225, v225, v201
    v_mfma_f32_16x16x32_bf16 v[104:107], v[40:43], a[104:107], v[104:107]
    ds_read_b64_tr_b16 a[174:175], v167 offset:288
    v_cvt_pk_bf16_f32 v68, v92, v64
    v_mfma_f32_16x16x32_bf16 v[204:207], v[60:63], a[108:111], 0
    ds_read_b64_tr_b16 a[176:177], v165 offset:36992
    v_cvt_pk_bf16_f32 v208, v93, v65
    v_mfma_f32_16x16x32_bf16 v[204:207], v[140:143], a[112:115], v[204:207]
    ds_read_b64_tr_b16 a[178:179], v165 offset:40064
    v_cvt_pk_bf16_f32 v128, v94, v66
    v_mfma_f32_16x16x32_bf16 v[204:207], v[40:43], a[116:119], v[204:207]
    ds_read_b64_tr_b16 a[180:181], v165 offset:43136
    v_cvt_pk_bf16_f32 v144, v95, v67
    v_mfma_f32_16x16x32_bf16 v[32:35], v[60:63], a[124:127], 0
    ds_read_b64_tr_b16 a[182:183], v167 offset:320
    v_mul_f32 v222, v222, v201
    v_mfma_f32_16x16x32_bf16 v[32:35], v[140:143], a[120:123], v[32:35]
    ds_read_b64_tr_b16 a[184:185], v166 offset:36992
    v_mul_f32 v226, v226, v201
    v_mfma_f32_16x16x32_bf16 v[32:35], v[40:43], a[128:131], v[32:35]
    ds_read_b64_tr_b16 a[186:187], v166 offset:40064
    v_cvt_pk_bf16_f32 v69, v104, v204
    v_mfma_f32_16x16x32_bf16 v[112:115], v[60:63], a[132:135], 0
    ds_read_b64_tr_b16 a[188:189], v166 offset:43136
    v_cvt_pk_bf16_f32 v209, v105, v205
    v_mfma_f32_16x16x32_bf16 v[112:115], v[140:143], a[136:139], v[112:115]
    ds_read_b64_tr_b16 a[190:191], v167 offset:352
    v_cvt_pk_bf16_f32 v129, v106, v206
    v_mfma_f32_16x16x32_bf16 v[112:115], v[40:43], a[140:143], v[112:115]
    v_exp_f32 v91, v91
    v_exp_f32 v96, v96
    v_exp_f32 v97, v97
    v_exp_f32 v98, v98
    v_exp_f32 v99, v99
    v_cvt_pk_bf16_f32 v121, v90, v91
    v_cvt_pk_bf16_f32 v122, v96, v97
    v_cvt_pk_bf16_f32 v123, v98, v99
    v_cvt_pk_bf16_f32 v145, v107, v207
    v_mul_f32 v223, v223, v201
    v_mfma_f32_16x16x32_bf16 v[72:75], v[180:183], v[120:123], 0
    v_mul_f32 v227, v227, v201
    v_cvt_pk_bf16_f32 v232, v220, v224
    v_mfma_f32_16x16x32_bf16 v[72:75], v[180:183], v[184:187], v[72:75]
    v_cvt_pk_bf16_f32 v233, v221, v225
    v_cvt_pk_bf16_f32 v234, v222, v226
    v_mfma_f32_16x16x32_bf16 v[48:51], a[144:147], v[120:123], 0
    v_cvt_pk_bf16_f32 v235, v223, v227
    v_mul_f32 v228, v228, v201
    v_mfma_f32_16x16x32_bf16 v[48:51], a[148:151], v[184:187], v[48:51]
    v_mul_f32 v16, v16, v201
    v_mul_f32 v229, v229, v201
    v_mfma_f32_16x16x32_bf16 v[108:111], a[152:155], v[120:123], 0
    v_mul_f32 v17, v17, v201
    v_mul_f32 v230, v230, v201
    v_mfma_f32_16x16x32_bf16 v[108:111], a[156:159], v[184:187], v[108:111]
    s_waitcnt lgkmcnt(0)
    v_mul_f32 v18, v18, v201
    v_mul_f32 v231, v231, v201
    v_mfma_f32_16x16x32_bf16 v[64:67], a[160:163], v[120:123], 0
    v_mul_f32 v19, v19, v201
    v_cvt_pk_bf16_f32 v70, v32, v112
    v_mfma_f32_16x16x32_bf16 v[64:67], a[164:167], v[184:187], v[64:67]
    v_cvt_pk_bf16_f32 v210, v33, v113
    v_cvt_pk_bf16_f32 v130, v34, v114
    v_mfma_f32_16x16x32_bf16 v[92:95], a[168:171], v[120:123], 0
    v_cvt_pk_bf16_f32 v146, v35, v115
    v_cvt_pk_bf16_f32 v60, v228, v16
    v_mfma_f32_16x16x32_bf16 v[92:95], a[172:175], v[184:187], v[92:95]
    v_cvt_pk_bf16_f32 v61, v229, v17
    v_cvt_pk_bf16_f32 v62, v230, v18
    v_mfma_f32_16x16x32_bf16 v[140:143], a[176:179], v[120:123], 0
    v_cvt_pk_bf16_f32 v63, v231, v19
    v_mul_f32 v20, v20, v201
    v_mfma_f32_16x16x32_bf16 v[140:143], a[180:183], v[184:187], v[140:143]
    v_mul_f32 v156, v156, v201
    v_mul_f32 v21, v21, v201
    v_mfma_f32_16x16x32_bf16 v[40:43], a[184:187], v[120:123], 0
    v_mul_f32 v157, v157, v201
    v_mul_f32 v22, v22, v201
    v_mfma_f32_16x16x32_bf16 v[40:43], a[188:191], v[184:187], v[40:43]
    v_mul_f32 v158, v158, v201
    v_mul_f32 v23, v23, v201
    v_mfma_f32_16x16x32_bf16 v[88:91], v[232:235], a[72:75], 0
    v_mul_f32 v159, v159, v201
    v_cvt_pk_bf16_f32 v96, v20, v156
    v_mfma_f32_16x16x32_bf16 v[88:91], v[60:63], a[76:79], v[88:91]
    v_cvt_pk_bf16_f32 v97, v21, v157
    v_cvt_pk_bf16_f32 v98, v22, v158
    v_cvt_pk_bf16_f32 v99, v23, v159
    v_mul_f32 v80, v80, v203
    v_mul_f32 v36, v36, v203
    v_mfma_f32_16x16x32_bf16 v[88:91], v[96:99], a[80:83], v[88:91]
    v_mul_f32 v81, v81, v203
    v_mul_f32 v37, v37, v203
    v_mfma_f32_16x16x32_bf16 v[104:107], v[232:235], a[84:87], 0
    v_mul_f32 v82, v82, v203
    v_mul_f32 v38, v38, v203
    v_mfma_f32_16x16x32_bf16 v[104:107], v[60:63], a[88:91], v[104:107]
    v_mul_f32 v83, v83, v203
    v_mul_f32 v39, v39, v203
    v_mfma_f32_16x16x32_bf16 v[104:107], v[96:99], a[92:95], v[104:107]
    v_cvt_pk_bf16_f32 v204, v80, v36
    v_cvt_pk_bf16_f32 v205, v81, v37
    v_mfma_f32_16x16x32_bf16 v[220:223], v[232:235], a[96:99], 0
    v_cvt_pk_bf16_f32 v206, v82, v38
    v_cvt_pk_bf16_f32 v207, v83, v39
    v_mfma_f32_16x16x32_bf16 v[220:223], v[60:63], a[100:103], v[220:223]
    v_mul_f32 v136, v136, v203
    v_mul_f32 v56, v56, v203
    v_mfma_f32_16x16x32_bf16 v[220:223], v[96:99], a[104:107], v[220:223]
    v_cvt_pk_bf16_f32 v224, v88, v104
    v_cvt_pk_bf16_f32 v32, v89, v105
    v_mfma_f32_16x16x32_bf16 v[112:115], v[232:235], a[108:111], 0
    buffer_store_dwordx3 v[68:70], v178, s[16:19], s30 offen offset:0 sc1 nt
    v_mfma_f32_16x16x32_bf16 v[112:115], v[60:63], a[112:115], v[112:115]
    v_cvt_pk_bf16_f32 v16, v90, v106
    v_cvt_pk_bf16_f32 v228, v91, v107
    v_mfma_f32_16x16x32_bf16 v[112:115], v[96:99], a[116:119], v[112:115]
    v_mul_f32 v137, v137, v203
    v_mul_f32 v57, v57, v203
    v_mfma_f32_16x16x32_bf16 v[120:123], v[232:235], a[124:127], 0
    v_mul_f32 v138, v138, v203
    v_mul_f32 v58, v58, v203
    v_mfma_f32_16x16x32_bf16 v[120:123], v[60:63], a[120:123], v[120:123]
    v_mul_f32 v139, v139, v203
    v_mul_f32 v59, v59, v203
    v_mfma_f32_16x16x32_bf16 v[120:123], v[96:99], a[128:131], v[120:123]
    v_cvt_pk_bf16_f32 v225, v220, v112
    v_cvt_pk_bf16_f32 v33, v221, v113
    v_mfma_f32_16x16x32_bf16 v[20:23], v[232:235], a[132:135], 0
    v_cvt_pk_bf16_f32 v17, v222, v114
    v_cvt_pk_bf16_f32 v229, v223, v115
    v_mfma_f32_16x16x32_bf16 v[20:23], v[60:63], a[136:139], v[20:23]
    v_cvt_pk_bf16_f32 v156, v136, v56
    v_cvt_pk_bf16_f32 v157, v137, v57
    v_mfma_f32_16x16x32_bf16 v[20:23], v[96:99], a[140:143], v[20:23]
    v_cvt_pk_bf16_f32 v158, v138, v58
    v_cvt_pk_bf16_f32 v159, v139, v59
    v_mfma_f32_16x16x32_bf16 v[36:39], a[0:3], v[152:155], 0
    v_mul_f32 v148, v148, v203
    v_mul_f32 v160, v160, v203
    v_mfma_f32_16x16x32_bf16 v[36:39], a[4:7], v[28:31], v[36:39]
    buffer_store_dwordx3 v[208:210], v197, s[16:19], s30 offen offset:768 sc1 nt
    v_mfma_f32_16x16x32_bf16 v[36:39], a[8:11], v[24:27], v[36:39]
    s_add_u32 s30, s30, 9144576
    v_cvt_pk_bf16_f32 v226, v120, v20
    v_cvt_pk_bf16_f32 v34, v121, v21
    v_mfma_f32_16x16x32_bf16 v[80:83], a[12:15], v[152:155], 0
    v_cvt_pk_bf16_f32 v18, v122, v22
    v_cvt_pk_bf16_f32 v230, v123, v23
    v_mfma_f32_16x16x32_bf16 v[80:83], a[16:19], v[28:31], v[80:83]
    v_mul_f32 v149, v149, v203
    v_cvt_pk_bf16_f32 v68, v36, v37
    v_mfma_f32_16x16x32_bf16 v[80:83], a[20:23], v[24:27], v[80:83]
    v_cvt_pk_bf16_f32 v69, v38, v39
    v_mul_f32 v161, v161, v203
    v_mfma_f32_16x16x32_bf16 v[88:91], a[24:27], v[152:155], 0
    v_mul_f32 v150, v150, v203
    v_mul_f32 v162, v162, v203
    v_mfma_f32_16x16x32_bf16 v[88:91], a[28:31], v[28:31], v[88:91]
    v_mul_f32 v151, v151, v203
    v_mul_f32 v163, v163, v203
    v_mfma_f32_16x16x32_bf16 v[88:91], a[32:35], v[24:27], v[88:91]
    v_cvt_pk_bf16_f32 v70, v80, v81
    v_cvt_pk_bf16_f32 v71, v82, v83
    v_mfma_f32_16x16x32_bf16 v[104:107], a[36:39], v[152:155], 0
    v_cvt_pk_bf16_f32 v112, v148, v160
    v_cvt_pk_bf16_f32 v113, v149, v161
    v_mfma_f32_16x16x32_bf16 v[104:107], a[40:43], v[28:31], v[104:107]
    buffer_store_dwordx3 v[128:130], v178, s[16:19], s31 offen offset:192 sc1 nt
    v_mfma_f32_16x16x32_bf16 v[104:107], a[44:47], v[24:27], v[104:107]
    v_cvt_pk_bf16_f32 v220, v88, v89
    v_cvt_pk_bf16_f32 v221, v90, v91
    v_mfma_f32_16x16x32_bf16 v[232:235], a[48:51], v[152:155], 0
    v_cvt_pk_bf16_f32 v114, v150, v162
    v_cvt_pk_bf16_f32 v115, v151, v163
    v_mfma_f32_16x16x32_bf16 v[232:235], a[52:55], v[28:31], v[232:235]
    v_exp_f32 v212, v212
    v_mfma_f32_16x16x32_bf16 v[232:235], a[56:59], v[24:27], v[232:235]
    v_cvt_pk_bf16_f32 v222, v104, v105
    v_cvt_pk_bf16_f32 v223, v106, v107
    v_mfma_f32_16x16x32_bf16 v[56:59], a[60:63], v[152:155], 0
    v_exp_f32 v213, v213
    v_mfma_f32_16x16x32_bf16 v[56:59], a[64:67], v[28:31], v[56:59]
    v_exp_f32 v214, v214
    v_mfma_f32_16x16x32_bf16 v[56:59], a[68:71], v[24:27], v[56:59]
    v_exp_f32 v215, v215
    v_mfma_f32_16x16x32_bf16 v[136:139], v[76:79], v[68:71], 0
    v_cvt_pk_bf16_f32 v60, v232, v233
    v_cvt_pk_bf16_f32 v61, v234, v235
    v_mfma_f32_16x16x32_bf16 v[136:139], v[132:135], v[220:223], v[136:139]
    buffer_store_dwordx3 v[144:146], v179, s[16:19], s31 offen offset:960 sc1 nt
    v_exp_f32 v84, v84
    v_exp_f32 v85, v85
    v_cvt_pk_bf16_f32 v62, v56, v57
    v_cvt_pk_bf16_f32 v63, v58, v59
    v_exp_f32 v86, v86
    v_exp_f32 v87, v87
    v_mfma_f32_16x16x32_bf16 v[136:139], v[236:239], v[60:63], v[136:139]
    s_add_u32 s31, s31, 9144576
    v_cvt_pk_bf16_f32 v96, v212, v213
    v_cvt_pk_bf16_f32 v97, v214, v215
    v_mfma_f32_16x16x32_bf16 v[208:211], v[216:219], v[68:71], 0
    v_cvt_pk_bf16_f32 v98, v84, v85
    v_cvt_pk_bf16_f32 v99, v86, v87
    v_mfma_f32_16x16x32_bf16 v[208:211], v[52:55], v[220:223], v[208:211]
    v_rcp_f32 v13, v72
    v_mfma_f32_16x16x32_bf16 v[208:211], v[124:127], v[60:63], v[208:211]
    v_mul_f32 v48, v48, v13
    v_mul_f32 v108, v108, v13
    v_mfma_f32_16x16x32_bf16 v[20:23], v[152:155], v[68:71], 0
    v_mul_f32 v49, v49, v13
    v_mul_f32 v109, v109, v13
    v_mfma_f32_16x16x32_bf16 v[20:23], v[28:31], v[220:223], v[20:23]
    v_mul_f32 v50, v50, v13
    v_mul_f32 v110, v110, v13
    v_mfma_f32_16x16x32_bf16 v[20:23], v[24:27], v[60:63], v[20:23]
    v_mul_f32 v51, v51, v13
    v_mul_f32 v111, v111, v13
    v_mfma_f32_16x16x32_bf16 v[120:123], v[204:207], a[72:75], 0
    v_cvt_pk_bf16_f32 v36, v48, v108
    v_cvt_pk_bf16_f32 v37, v49, v109
    v_mfma_f32_16x16x32_bf16 v[120:123], v[156:159], a[76:79], v[120:123]
    v_cvt_pk_bf16_f32 v38, v50, v110
    v_cvt_pk_bf16_f32 v39, v51, v111
    v_mfma_f32_16x16x32_bf16 v[120:123], v[112:115], a[80:83], v[120:123]
    buffer_store_dwordx3 v[224:226], v178, s[16:19], s32 offen offset:384 sc1 nt
    v_mfma_f32_16x16x32_bf16 v[200:203], v[204:207], a[84:87], 0
    v_exp_f32 v20, v20
    v_mfma_f32_16x16x32_bf16 v[200:203], v[156:159], a[88:91], v[200:203]
    ds_read_b128 v[80:83], v170 offset:3584
    v_mul_f32 v64, v64, v13
    v_mfma_f32_16x16x32_bf16 v[200:203], v[112:115], a[92:95], v[200:203]
    v_exp_f32 v21, v21
    v_mfma_f32_16x16x32_bf16 v[128:131], v[204:207], a[96:99], 0
    v_exp_f32 v22, v22
    v_mfma_f32_16x16x32_bf16 v[128:131], v[156:159], a[100:103], v[128:131]
    v_exp_f32 v23, v23
    v_mfma_f32_16x16x32_bf16 v[128:131], v[112:115], a[104:107], v[128:131]
    v_cvt_pk_bf16_f32 v192, v20, v21
    v_cvt_pk_bf16_f32 v193, v22, v23
    v_mfma_f32_16x16x32_bf16 v[88:91], v[204:207], a[108:111], 0
    v_cvt_pk_bf16_f32 v148, v120, v200
    v_cvt_pk_bf16_f32 v160, v121, v201
    v_mfma_f32_16x16x32_bf16 v[88:91], v[156:159], a[112:115], v[88:91]
    v_cvt_pk_bf16_f32 v104, v122, v202
    v_cvt_pk_bf16_f32 v232, v123, v203
    v_mfma_f32_16x16x32_bf16 v[88:91], v[112:115], a[116:119], v[88:91]
    s_waitcnt lgkmcnt(0)
    v_add_f32 v80, v80, v81
    v_add_f32 v80, v80, v82
    v_mfma_f32_16x16x32_bf16 v[144:147], v[204:207], a[124:127], 0
    buffer_store_dwordx3 v[32:34], v196, s[16:19], s32 offen offset:1152 sc1 nt
    v_mfma_f32_16x16x32_bf16 v[144:147], v[156:159], a[120:123], v[144:147]
    s_add_u32 s32, s32, 9144576
    v_cndmask_b32 v198, v177, v80, s[56:57]
    v_cndmask_b32 v198, v198, v45, s[50:51]
    v_mfma_f32_16x16x32_bf16 v[144:147], v[112:115], a[128:131], v[144:147]
    v_cndmask_b32 v198, v198, v117, s[52:53]
    v_cndmask_b32 v198, v198, v101, s[54:55]
    v_mfma_f32_16x16x32_bf16 v[76:79], v[204:207], a[132:135], 0
    v_exp_f32 v198, v198
    v_mfma_f32_16x16x32_bf16 v[76:79], v[156:159], a[136:139], v[76:79]
    v_cvt_pk_bf16_f32 v198, v198, v198
    v_cvt_pk_bf16_f32 v149, v128, v88
    v_mfma_f32_16x16x32_bf16 v[76:79], v[112:115], a[140:143], v[76:79]
    ds_write_b16 v171, v198 offset:576
    v_mfma_f32_16x16x32_bf16 v[56:59], v[180:183], v[96:99], 0
    ds_read2_b64 v[132:135], v172 offset0:72 offset1:76
    v_cvt_pk_bf16_f32 v161, v129, v89
    v_mfma_f32_16x16x32_bf16 v[56:59], v[180:183], v[188:191], v[56:59]
    ds_read2_b64 v[212:215], v172 offset0:80 offset1:84
    v_cvt_pk_bf16_f32 v105, v130, v90
    v_mfma_f32_16x16x32_bf16 v[84:87], a[144:147], v[96:99], 0
    v_cvt_pk_bf16_f32 v233, v131, v91
    v_cvt_pk_bf16_f32 v150, v144, v76
    v_mfma_f32_16x16x32_bf16 v[84:87], a[148:151], v[188:191], v[84:87]
    buffer_store_dwordx3 v[16:18], v178, s[16:19], s33 offen offset:576 sc1 nt
    v_mfma_f32_16x16x32_bf16 v[236:239], a[152:155], v[96:99], 0
    s_add_u32 s33, s33, 9144576
    v_cvt_pk_bf16_f32 v162, v145, v77
    v_cvt_pk_bf16_f32 v106, v146, v78
    v_mfma_f32_16x16x32_bf16 v[236:239], a[156:159], v[188:191], v[236:239]
    v_cvt_pk_bf16_f32 v234, v147, v79
    v_mul_f32 v92, v92, v13
    v_mfma_f32_16x16x32_bf16 v[72:75], a[160:163], v[96:99], 0
    v_mul_f32 v65, v65, v13
    v_mul_f32 v93, v93, v13
    v_mfma_f32_16x16x32_bf16 v[72:75], a[164:167], v[188:191], v[72:75]
    v_mul_f32 v66, v66, v13
    v_mul_f32 v94, v94, v13
    v_mfma_f32_16x16x32_bf16 v[216:219], a[168:171], v[96:99], 0
    v_mul_f32 v67, v67, v13
    v_mul_f32 v95, v95, v13
    v_mfma_f32_16x16x32_bf16 v[216:219], a[172:175], v[188:191], v[216:219]
    v_cvt_pk_bf16_f32 v52, v64, v92
    v_cvt_pk_bf16_f32 v53, v65, v93
    v_mfma_f32_16x16x32_bf16 v[124:127], a[176:179], v[96:99], 0
    v_cvt_pk_bf16_f32 v54, v66, v94
    v_cvt_pk_bf16_f32 v55, v67, v95
    v_mfma_f32_16x16x32_bf16 v[124:127], a[180:183], v[188:191], v[124:127]
    v_mul_f32 v140, v140, v13
    v_mul_f32 v40, v40, v13
    v_mfma_f32_16x16x32_bf16 v[68:71], a[184:187], v[96:99], 0
    s_waitcnt lgkmcnt(0)
    v_mul_f32 v141, v141, v13
    v_mul_f32 v41, v41, v13
    v_mfma_f32_16x16x32_bf16 v[68:71], a[188:191], v[188:191], v[68:71]
    buffer_store_dwordx3 v[228:230], v178, s[16:19], s34 offen offset:0 sc1 nt
    v_mfma_f32_16x16x32_bf16 v[152:155], v[132:135], v[180:183], 0
    v_mul_f32 v142, v142, v13
    v_mul_f32 v42, v42, v13
    v_mfma_f32_16x16x32_bf16 v[152:155], v[212:215], v[180:183], v[152:155]
    v_mul_f32 v143, v143, v13
    v_mul_f32 v43, v43, v13
    v_mfma_f32_16x16x32_bf16 v[28:31], v[132:135], a[144:147], 0
    v_cvt_pk_bf16_f32 v220, v140, v40
    v_cvt_pk_bf16_f32 v221, v141, v41
    v_mfma_f32_16x16x32_bf16 v[28:31], v[212:215], a[148:151], v[28:31]
    v_cvt_pk_bf16_f32 v222, v142, v42
    v_cvt_pk_bf16_f32 v223, v143, v43
    v_mfma_f32_16x16x32_bf16 v[24:27], v[132:135], a[152:155], 0
    v_cndmask_b32 v169, v169, v152, s[52:53]
    v_exp_f32 v136, v136
    v_mfma_f32_16x16x32_bf16 v[24:27], v[212:215], a[156:159], v[24:27]
    v_exp_f32 v137, v137
    v_mfma_f32_16x16x32_bf16 v[60:63], v[132:135], a[160:163], 0
L_h2:
    s_cbranch_execz L_hopret
    v_exp_f32 v138, v138
    v_mfma_f32_16x16x32_bf16 v[60:63], v[212:215], a[164:167], v[60:63]
    v_exp_f32 v139, v139
    v_mfma_f32_16x16x32_bf16 v[48:51], v[132:135], a[168:171], 0
    buffer_store_dwordx3 v[148:150], v197, s[16:19], s34 offen offset:768 sc1 nt
    v_mfma_f32_16x16x32_bf16 v[48:51], v[212:215], a[172:175], v[48:51]
    s_add_u32 s34, s34, 9144576
    v_cvt_pk_bf16_f32 v198, v28, v24
    v_cvt_pk_bf16_f32 v108, v136, v137
    v_mfma_f32_16x16x32_bf16 v[224:227], v[132:135], a[176:179], 0
    ds_write_b32 v173, v198 offset:3264
    v_mfma_f32_16x16x32_bf16 v[224:227], v[212:215], a[180:183], v[224:227]
    v_exp_f32 v208, v208
    v_mfma_f32_16x16x32_bf16 v[20:23], v[132:135], a[184:187], 0
    v_cvt_pk_bf16_f32 v198, v60, v48
    v_cvt_pk_bf16_f32 v109, v138, v139
    v_mfma_f32_16x16x32_bf16 v[20:23], v[212:215], a[188:191], v[20:23]
    ds_write_b32 v173, v198 offset:3328
    v_mfma_f32_16x16x32_bf16 v[120:123], v[36:39], a[72:75], 0
    v_exp_f32 v209, v209
    v_mfma_f32_16x16x32_bf16 v[120:123], v[52:55], a[76:79], v[120:123]
    v_exp_f32 v210, v210
    v_mfma_f32_16x16x32_bf16 v[120:123], v[220:223], a[80:83], v[120:123]
    v_exp_f32 v211, v211
    v_mfma_f32_16x16x32_bf16 v[200:203], v[36:39], a[84:87], 0
    v_cvt_pk_bf16_f32 v198, v224, v20
    v_cvt_pk_bf16_f32 v110, v208, v209
    v_mfma_f32_16x16x32_bf16 v[200:203], v[52:55], a[88:91], v[200:203]
    buffer_store_dwordx3 v[160:162], v178, s[16:19], s35 offen offset:192 sc1 nt
    v_mfma_f32_16x16x32_bf16 v[200:203], v[220:223], a[92:95], v[200:203]
    ds_write_b32 v173, v198 offset:3392
    v_mfma_f32_16x16x32_bf16 v[32:35], v[36:39], a[96:99], 0
    v_cvt_pk_bf16_f32 v111, v210, v211
    v_mfma_f32_16x16x32_bf16 v[32:35], v[52:55], a[100:103], v[32:35]
    v_rcp_f32 v198, v56
    v_mfma_f32_16x16x32_bf16 v[32:35], v[220:223], a[104:107], v[32:35]
    v_mul_f32 v84, v84, v198
    v_mul_f32 v236, v236, v198
    v_mfma_f32_16x16x32_bf16 v[80:83], v[36:39], a[108:111], 0
    v_cvt_pk_bf16_f32 v44, v120, v200
    v_cvt_pk_bf16_f32 v116, v121, v201
    v_mfma_f32_16x16x32_bf16 v[80:83], v[52:55], a[112:115], v[80:83]
    v_cvt_pk_bf16_f32 v100, v122, v202
    v_cvt_pk_bf16_f32 v204, v123, v203
    v_mfma_f32_16x16x32_bf16 v[80:83], v[220:223], a[116:119], v[80:83]
    v_mul_f32 v85, v85, v198
    v_mul_f32 v237, v237, v198
    v_mfma_f32_16x16x32_bf16 v[156:159], v[36:39], a[124:127], 0
    v_mul_f32 v86, v86, v198
    v_mul_f32 v238, v238, v198
    v_mfma_f32_16x16x32_bf16 v[156:159], v[52:55], a[120:123], v[156:159]
    buffer_store_dwordx3 v[104:106], v179, s[16:19], s35 offen offset:960 sc1 nt
    v_mfma_f32_16x16x32_bf16 v[156:159], v[220:223], a[128:131], v[156:159]
    s_add_u32 s35, s35, 9144576
    v_cvt_pk_bf16_f32 v45, v32, v80
    v_cvt_pk_bf16_f32 v117, v33, v81
    v_mfma_f32_16x16x32_bf16 v[112:115], v[36:39], a[132:135], 0
    v_cvt_pk_bf16_f32 v101, v34, v82
    v_cvt_pk_bf16_f32 v205, v35, v83
    v_mfma_f32_16x16x32_bf16 v[112:115], v[52:55], a[136:139], v[112:115]
    v_mul_f32 v87, v87, v198
    v_mul_f32 v239, v239, v198
    v_mfma_f32_16x16x32_bf16 v[112:115], v[220:223], a[140:143], v[112:115]
    v_cvt_pk_bf16_f32 v88, v84, v236
    v_cvt_pk_bf16_f32 v89, v85, v237
    v_mfma_f32_16x16x32_bf16 v[128:131], v[180:183], v[108:111], 0
    v_cvt_pk_bf16_f32 v90, v86, v238
    v_cvt_pk_bf16_f32 v91, v87, v239
    v_mfma_f32_16x16x32_bf16 v[128:131], v[180:183], v[192:195], v[128:131]
    s_waitcnt vmcnt(11)
    ds_read_b128 v[16:19], v174 offset:0
    v_mfma_f32_16x16x32_bf16 v[76:79], a[144:147], v[108:111], 0
    ds_read_b128 v[144:147], v174 offset:64
    v_cvt_pk_bf16_f32 v46, v156, v112
    v_mfma_f32_16x16x32_bf16 v[76:79], a[148:151], v[192:195], v[76:79]
    ds_read_b128 v[64:67], v174 offset:128
    v_cvt_pk_bf16_f32 v118, v157, v113
    v_mfma_f32_16x16x32_bf16 v[92:95], a[152:155], v[108:111], 0
    v_cvt_pk_bf16_f32 v102, v158, v114
    v_cvt_pk_bf16_f32 v206, v159, v115
    v_mfma_f32_16x16x32_bf16 v[92:95], a[156:159], v[192:195], v[92:95]
    buffer_store_dwordx3 v[232:234], v178, s[16:19], s36 offen offset:384 sc1 nt
    v_mfma_f32_16x16x32_bf16 v[228:231], a[160:163], v[108:111], 0
    s_add_u32 s36, s36, 9144576
    v_mul_f32 v72, v72, v198
    v_mul_f32 v216, v216, v198
    v_mfma_f32_16x16x32_bf16 v[228:231], a[164:167], v[192:195], v[228:231]
    v_mul_f32 v73, v73, v198
    v_mul_f32 v217, v217, v198
    v_mfma_f32_16x16x32_bf16 v[96:99], a[168:171], v[108:111], 0
    v_mul_f32 v74, v74, v198
    v_mul_f32 v218, v218, v198
    v_mfma_f32_16x16x32_bf16 v[96:99], a[172:175], v[192:195], v[96:99]
    v_mul_f32 v75, v75, v198
    v_mul_f32 v219, v219, v198
    v_mfma_f32_16x16x32_bf16 v[40:43], a[176:179], v[108:111], 0
    v_cvt_pk_bf16_f32 v140, v72, v216
    v_cvt_pk_bf16_f32 v141, v73, v217
    v_mfma_f32_16x16x32_bf16 v[40:43], a[180:183], v[192:195], v[40:43]
    v_cvt_pk_bf16_f32 v142, v74, v218
    v_cvt_pk_bf16_f32 v143, v75, v219
    v_mfma_f32_16x16x32_bf16 v[152:155], a[184:187], v[108:111], 0
    s_waitcnt lgkmcnt(0)
    v_mul_f32 v124, v124, v198
    v_mul_f32 v68, v68, v198
    v_mfma_f32_16x16x32_bf16 v[152:155], a[188:191], v[192:195], v[152:155]
    v_mul_f32 v125, v125, v198
    v_mul_f32 v69, v69, v198
    v_mfma_f32_16x16x32_bf16 v[148:151], a[0:3], v[16:19], 0
    buffer_store_dwordx3 v[44:46], v178, s[16:19], s30 offen offset:0 sc1 nt
    v_mfma_f32_16x16x32_bf16 v[148:151], a[4:7], v[144:147], v[148:151]
    v_mul_f32 v126, v126, v198
    v_mul_f32 v70, v70, v198
    v_mfma_f32_16x16x32_bf16 v[148:151], a[8:11], v[64:67], v[148:151]
    v_mul_f32 v127, v127, v198
    v_mul_f32 v71, v71, v198
    v_mfma_f32_16x16x32_bf16 v[24:27], a[12:15], v[16:19], 0
    v_cvt_pk_bf16_f32 v28, v124, v68
    v_cvt_pk_bf16_f32 v29, v125, v69
    v_mfma_f32_16x16x32_bf16 v[24:27], a[16:19], v[144:147], v[24:27]
    v_cvt_pk_bf16_f32 v30, v126, v70
    v_cvt_pk_bf16_f32 v31, v127, v71
    v_mfma_f32_16x16x32_bf16 v[24:27], a[20:23], v[64:67], v[24:27]
    v_cvt_pk_bf16_f32 v48, v148, v149
    v_cvt_pk_bf16_f32 v49, v150, v151
    v_mfma_f32_16x16x32_bf16 v[60:63], a[24:27], v[16:19], 0
    v_rcp_f32 v199, v128
    v_mfma_f32_16x16x32_bf16 v[60:63], a[28:31], v[144:147], v[60:63]
    v_max3_u32 v164, v13, v198, v199
    v_cmp_lt_u32 vcc, 0x4b800000, v164
    v_mfma_f32_16x16x32_bf16 v[60:63], a[32:35], v[64:67], v[60:63]
    v_cvt_pk_bf16_f32 v50, v24, v25
    v_cvt_pk_bf16_f32 v51, v26, v27
    v_mfma_f32_16x16x32_bf16 v[136:139], a[36:39], v[16:19], 0
    s_or_b64 s[58:59], s[58:59], vcc
    v_min3_u32 v164, v13, v198, v199
    v_cmp_gt_u32 vcc, 0x27800000, v164
    v_mfma_f32_16x16x32_bf16 v[136:139], a[40:43], v[144:147], v[136:139]
    buffer_store_dwordx3 v[116:118], v197, s[16:19], s30 offen offset:768 sc1 nt
    v_mfma_f32_16x16x32_bf16 v[136:139], a[44:47], v[64:67], v[136:139]
    s_or_b64 s[58:59], s[58:59], vcc
    v_cvt_pk_bf16_f32 v132, v60, v61
    v_cvt_pk_bf16_f32 v133, v62, v63
    v_mfma_f32_16x16x32_bf16 v[212:215], a[48:51], v[16:19], 0
    s_add_u32 s30, s30, 9144576
    v_mul_f32 v76, v76, v199
    v_mul_f32 v92, v92, v199
    v_mfma_f32_16x16x32_bf16 v[212:215], a[52:55], v[144:147], v[212:215]
    v_cvt_pk_bf16_f32 v134, v136, v137
    v_cvt_pk_bf16_f32 v135, v138, v139
    v_mfma_f32_16x16x32_bf16 v[212:215], a[56:59], v[64:67], v[212:215]
    v_mul_f32 v77, v77, v199
    v_mul_f32 v93, v93, v199
    v_mfma_f32_16x16x32_bf16 v[20:23], a[60:63], v[16:19], 0
    v_mul_f32 v78, v78, v199
    v_mul_f32 v94, v94, v199
    v_mfma_f32_16x16x32_bf16 v[20:23], a[64:67], v[144:147], v[20:23]
    v_mul_f32 v79, v79, v199
    v_mul_f32 v95, v95, v199
    v_mfma_f32_16x16x32_bf16 v[20:23], a[68:71], v[64:67], v[20:23]
    v_cvt_pk_bf16_f32 v224, v212, v213
    v_cvt_pk_bf16_f32 v225, v214, v215
    v_mfma_f32_16x16x32_bf16 v[160:163], v[88:91], a[72:75], 0
    v_cvt_pk_bf16_f32 v208, v76, v92
    v_cvt_pk_bf16_f32 v209, v77, v93
    v_mfma_f32_16x16x32_bf16 v[160:163], v[140:143], a[76:79], v[160:163]
    buffer_store_dwordx3 v[100:102], v178, s[16:19], s31 offen offset:192 sc1 nt
    v_mfma_f32_16x16x32_bf16 v[160:163], v[28:31], a[80:83], v[160:163]
    v_cvt_pk_bf16_f32 v226, v20, v21
    v_cvt_pk_bf16_f32 v227, v22, v23
    v_mfma_f32_16x16x32_bf16 v[56:59], v[88:91], a[84:87], 0
    ds_read_b128 v[120:123], v174 offset:3072
    v_cvt_pk_bf16_f32 v210, v78, v94
    v_mfma_f32_16x16x32_bf16 v[56:59], v[140:143], a[88:91], v[56:59]
    ds_read_b128 v[200:203], v174 offset:3136
    v_cvt_pk_bf16_f32 v211, v79, v95
    v_mfma_f32_16x16x32_bf16 v[56:59], v[28:31], a[92:95], v[56:59]
    ds_read_b128 v[104:107], v174 offset:3200
    v_mul_f32 v228, v228, v199
    v_mfma_f32_16x16x32_bf16 v[32:35], v[88:91], a[96:99], 0
    ds_read_b128 v[80:83], v174 offset:6144
    v_mul_f32 v96, v96, v199
    v_mfma_f32_16x16x32_bf16 v[32:35], v[140:143], a[100:103], v[32:35]
    ds_read_b128 v[36:39], v174 offset:6208
    v_mul_f32 v229, v229, v199
    v_mfma_f32_16x16x32_bf16 v[32:35], v[28:31], a[104:107], v[32:35]
    ds_read_b128 v[52:55], v174 offset:6272
    v_cvt_pk_bf16_f32 v84, v160, v56
    v_mfma_f32_16x16x32_bf16 v[236:239], v[88:91], a[108:111], 0
    ds_read_b128 v[220:223], v168 offset:5760
    v_cvt_pk_bf16_f32 v112, v161, v57
    v_mfma_f32_16x16x32_bf16 v[236:239], v[140:143], a[112:115], v[236:239]
    ds_read_b128 v[156:159], v168 offset:5824
    v_cvt_pk_bf16_f32 v232, v162, v58
    v_mfma_f32_16x16x32_bf16 v[236:239], v[28:31], a[116:119], v[236:239]
    buffer_store_dwordx3 v[204:206], v179, s[16:19], s31 offen offset:960 sc1 nt
    v_mfma_f32_16x16x32_bf16 v[72:75], v[88:91], a[124:127], 0
    ds_read_b128 v[216:219], v168 offset:5888
    v_cvt_pk_bf16_f32 v108, v163, v59
    v_mfma_f32_16x16x32_bf16 v[72:75], v[140:143], a[120:123], v[72:75]
    s_add_u32 s31, s31, 9144576
    v_mul_f32 v97, v97, v199
    v_mul_f32 v230, v230, v199
    v_mfma_f32_16x16x32_bf16 v[72:75], v[28:31], a[128:131], v[72:75]
    v_cvt_pk_bf16_f32 v85, v32, v236
    v_cvt_pk_bf16_f32 v113, v33, v237
    v_mfma_f32_16x16x32_bf16 v[44:47], v[88:91], a[132:135], 0
    v_cvt_pk_bf16_f32 v233, v34, v238
    v_cvt_pk_bf16_f32 v109, v35, v239
    v_mfma_f32_16x16x32_bf16 v[44:47], v[140:143], a[136:139], v[44:47]
    v_mul_f32 v98, v98, v199
    v_mul_f32 v231, v231, v199
    v_mfma_f32_16x16x32_bf16 v[44:47], v[28:31], a[140:143], v[44:47]
    v_mul_f32 v99, v99, v199
    v_cvt_pk_bf16_f32 v68, v228, v96
    v_mfma_f32_16x16x32_bf16 v[124:127], v[16:19], v[48:51], 0
    v_cvt_pk_bf16_f32 v69, v229, v97
    v_cvt_pk_bf16_f32 v70, v230, v98
    v_mfma_f32_16x16x32_bf16 v[124:127], v[144:147], v[132:135], v[124:127]
    s_waitcnt lgkmcnt(0)
    v_cvt_pk_bf16_f32 v71, v231, v99
    v_cvt_pk_bf16_f32 v86, v72, v44
    v_mfma_f32_16x16x32_bf16 v[124:127], v[64:67], v[224:227], v[124:127]
    buffer_store_dwordx3 v[84:86], v178, s[16:19], s32 offen offset:384 sc1 nt
    v_mfma_f32_16x16x32_bf16 v[148:151], v[120:123], v[48:51], 0
    v_cvt_pk_bf16_f32 v114, v73, v45
    v_cvt_pk_bf16_f32 v234, v74, v46
    v_mfma_f32_16x16x32_bf16 v[148:151], v[200:203], v[132:135], v[148:151]
    v_cvt_pk_bf16_f32 v110, v75, v47
    v_mul_f32 v40, v40, v199
    v_mfma_f32_16x16x32_bf16 v[148:151], v[104:107], v[224:227], v[148:151]
    v_mul_f32 v152, v152, v199
    v_mul_f32 v41, v41, v199
    v_mfma_f32_16x16x32_bf16 v[128:131], v[80:83], v[48:51], 0
    v_mul_f32 v153, v153, v199
    v_mul_f32 v42, v42, v199
    v_mfma_f32_16x16x32_bf16 v[128:131], v[36:39], v[132:135], v[128:131]
    v_mul_f32 v154, v154, v199
    v_mul_f32 v43, v43, v199
    v_mfma_f32_16x16x32_bf16 v[128:131], v[52:55], v[224:227], v[128:131]
    v_mul_f32 v155, v155, v199
    v_cvt_pk_bf16_f32 v24, v40, v152
    v_mfma_f32_16x16x32_bf16 v[116:119], v[220:223], v[16:19], 0
    v_cvt_pk_bf16_f32 v25, v41, v153
    v_cvt_pk_bf16_f32 v26, v42, v154
    v_mfma_f32_16x16x32_bf16 v[116:119], v[156:159], v[144:147], v[116:119]
    v_cvt_pk_bf16_f32 v27, v43, v155
    v_mfma_f32_16x16x32_bf16 v[116:119], v[216:219], v[64:67], v[116:119]
    v_exp_f32 v128, v128
    v_mfma_f32_16x16x32_bf16 v[60:63], v[220:223], v[120:123], 0
    buffer_store_dwordx3 v[112:114], v196, s[16:19], s32 offen offset:1152 sc1 nt
    v_mfma_f32_16x16x32_bf16 v[60:63], v[156:159], v[200:203], v[60:63]
    s_add_u32 s32, s32, 9144576
    v_exp_f32 v129, v129
    v_mfma_f32_16x16x32_bf16 v[60:63], v[216:219], v[104:107], v[60:63]
    v_exp_f32 v130, v130
    v_mfma_f32_16x16x32_bf16 v[136:139], v[220:223], v[80:83], 0
    v_cndmask_b32 v13, v177, v116, s[50:51]
    v_cvt_pk_bf16_f32 v184, v128, v129
    v_mfma_f32_16x16x32_bf16 v[136:139], v[156:159], v[36:39], v[136:139]
    v_exp_f32 v131, v131
    v_mfma_f32_16x16x32_bf16 v[136:139], v[216:219], v[52:55], v[136:139]
    v_exp_f32 v13, v13
    v_mfma_f32_16x16x32_bf16 v[212:215], a[0:3], v[120:123], 0
    ds_read_b64_tr_b16 a[192:193], v175 offset:0
    v_cvt_pk_bf16_f32 v185, v130, v131
    v_mfma_f32_16x16x32_bf16 v[212:215], a[4:7], v[200:203], v[212:215]
    ds_read_b64_tr_b16 a[194:195], v175 offset:3072
    v_cvt_pk_bf16_f32 v186, v13, 0
    v_mfma_f32_16x16x32_bf16 v[212:215], a[8:11], v[104:107], v[212:215]
    ds_read_b64_tr_b16 a[220:221], v175 offset:6144
    v_cndmask_b32 v13, v177, v60, s[50:51]
    v_mfma_f32_16x16x32_bf16 v[100:103], a[12:15], v[120:123], 0
    buffer_store_dwordx3 v[232:234], v178, s[16:19], s33 offen offset:576 sc1 nt
    v_mfma_f32_16x16x32_bf16 v[100:103], a[16:19], v[200:203], v[100:103]
    ds_read_b64_tr_b16 a[222:223], v167 offset:384
    v_cndmask_b32 v168, v177, v136, s[50:51]
    v_mfma_f32_16x16x32_bf16 v[100:103], a[20:23], v[104:107], v[100:103]
    ds_read_b64_tr_b16 a[224:225], v176 offset:0
    v_cvt_pk_bf16_f32 v20, v212, v213
    v_mfma_f32_16x16x32_bf16 v[76:79], a[24:27], v[120:123], 0
    ds_read_b64_tr_b16 a[226:227], v176 offset:3072
    v_cvt_pk_bf16_f32 v21, v214, v215
    v_mfma_f32_16x16x32_bf16 v[76:79], a[28:31], v[200:203], v[76:79]
    ds_read_b64_tr_b16 a[228:229], v176 offset:6144
    s_add_u32 s33, s33, 9144576
    v_mfma_f32_16x16x32_bf16 v[76:79], a[32:35], v[104:107], v[76:79]
    ds_read_b64_tr_b16 a[230:231], v167 offset:416
    v_cvt_pk_bf16_f32 v22, v100, v101
    v_mfma_f32_16x16x32_bf16 v[92:95], a[36:39], v[120:123], 0
    ds_read_b64_tr_b16 a[196:197], v175 offset:64
    v_cvt_pk_bf16_f32 v23, v102, v103
    v_mfma_f32_16x16x32_bf16 v[92:95], a[40:43], v[200:203], v[92:95]
    ds_read_b64_tr_b16 a[198:199], v175 offset:3136
    v_exp_f32 v13, v13
    v_mfma_f32_16x16x32_bf16 v[92:95], a[44:47], v[104:107], v[92:95]
    ds_read_b64_tr_b16 a[200:201], v175 offset:6208
    v_cvt_pk_bf16_f32 v190, v13, 0
    v_mfma_f32_16x16x32_bf16 v[204:207], a[48:51], v[120:123], 0
    ds_read_b64_tr_b16 a[202:203], v167 offset:448
    v_cvt_pk_bf16_f32 v56, v76, v77
    v_mfma_f32_16x16x32_bf16 v[204:207], a[52:55], v[200:203], v[204:207]
    buffer_store_dwordx3 v[108:110], v178, s[16:19], s34 offen offset:0 sc1 nt
    v_mfma_f32_16x16x32_bf16 v[204:207], a[56:59], v[104:107], v[204:207]
    ds_read_b64_tr_b16 a[204:205], v176 offset:64
    v_cvt_pk_bf16_f32 v57, v78, v79
    v_mfma_f32_16x16x32_bf16 v[160:163], a[60:63], v[120:123], 0
    ds_read_b64_tr_b16 a[206:207], v176 offset:3136
    v_cvt_pk_bf16_f32 v58, v92, v93
    v_mfma_f32_16x16x32_bf16 v[160:163], a[64:67], v[200:203], v[160:163]
    ds_read_b64_tr_b16 a[208:209], v176 offset:6208
    v_cvt_pk_bf16_f32 v59, v94, v95
    v_mfma_f32_16x16x32_bf16 v[160:163], a[68:71], v[104:107], v[160:163]
    ds_read_b64_tr_b16 a[210:211], v167 offset:480
    v_cvt_pk_bf16_f32 v32, v204, v205
    v_mfma_f32_16x16x32_bf16 v[236:239], v[208:211], a[72:75], 0
    ds_read_b64_tr_b16 a[212:213], v175 offset:128
    v_cvt_pk_bf16_f32 v33, v206, v207
    v_mfma_f32_16x16x32_bf16 v[236:239], v[68:71], a[76:79], v[236:239]
    ds_read_b64_tr_b16 a[214:215], v175 offset:3200
    v_exp_f32 v168, v168
    v_mfma_f32_16x16x32_bf16 v[236:239], v[24:27], a[80:83], v[236:239]
    ds_read_b64_tr_b16 a[216:217], v175 offset:6272
    v_cvt_pk_bf16_f32 v194, v168, 0
    v_mfma_f32_16x16x32_bf16 v[88:91], v[208:211], a[84:87], 0
    ds_read_b64_tr_b16 a[218:219], v167 offset:512
    v_cvt_pk_bf16_f32 v34, v160, v161
    v_mfma_f32_16x16x32_bf16 v[88:91], v[68:71], a[88:91], v[88:91]
    ds_read_b64_tr_b16 a[232:233], v176 offset:128
    v_cvt_pk_bf16_f32 v35, v162, v163
    v_mfma_f32_16x16x32_bf16 v[88:91], v[24:27], a[92:95], v[88:91]
    ds_read_b64_tr_b16 a[234:235], v176 offset:3200
    v_exp_f32 v124, v124
    v_mfma_f32_16x16x32_bf16 v[140:143], v[208:211], a[96:99], 0
    ds_read_b64_tr_b16 a[244:245], v176 offset:6272
    v_exp_f32 v125, v125
    v_mfma_f32_16x16x32_bf16 v[140:143], v[68:71], a[100:103], v[140:143]
    ds_read_b64_tr_b16 a[246:247], v167 offset:544
    v_cvt_pk_bf16_f32 v28, v124, v125
    v_mfma_f32_16x16x32_bf16 v[140:143], v[24:27], a[104:107], v[140:143]
    v_cvt_pk_bf16_f32 v96, v236, v88
    v_cvt_pk_bf16_f32 v228, v237, v89
    v_mfma_f32_16x16x32_bf16 v[84:87], v[208:211], a[108:111], 0
    v_cvt_pk_bf16_f32 v44, v238, v90
    v_cvt_pk_bf16_f32 v72, v239, v91
    v_mfma_f32_16x16x32_bf16 v[84:87], v[68:71], a[112:115], v[84:87]
    v_exp_f32 v126, v126
    v_mfma_f32_16x16x32_bf16 v[84:87], v[24:27], a[116:119], v[84:87]
    v_exp_f32 v127, v127
    v_mfma_f32_16x16x32_bf16 v[48:51], v[208:211], a[124:127], 0
    v_exp_f32 v148, v148
    v_mfma_f32_16x16x32_bf16 v[48:51], v[68:71], a[120:123], v[48:51]
    v_exp_f32 v149, v149
    v_mfma_f32_16x16x32_bf16 v[48:51], v[24:27], a[128:131], v[48:51]
    v_exp_f32 v150, v150
    v_mfma_f32_16x16x32_bf16 v[132:135], v[208:211], a[132:135], 0
    v_cvt_pk_bf16_f32 v97, v140, v84
    v_cvt_pk_bf16_f32 v229, v141, v85
    v_mfma_f32_16x16x32_bf16 v[132:135], v[68:71], a[136:139], v[132:135]
    v_exp_f32 v151, v151
    v_mfma_f32_16x16x32_bf16 v[132:135], v[24:27], a[140:143], v[132:135]
    v_cvt_pk_bf16_f32 v45, v142, v86
    v_cvt_pk_bf16_f32 v73, v143, v87
    v_mfma_f32_16x16x32_bf16 v[224:227], v[16:19], v[20:23], 0
    v_cvt_pk_bf16_f32 v29, v126, v127
    v_cvt_pk_bf16_f32 v30, v148, v149
    v_mfma_f32_16x16x32_bf16 v[224:227], v[144:147], v[56:59], v[224:227]
    v_cvt_pk_bf16_f32 v31, v150, v151
    v_mfma_f32_16x16x32_bf16 v[224:227], v[64:67], v[32:35], v[224:227]
    v_cvt_pk_bf16_f32 v98, v48, v132
    v_cvt_pk_bf16_f32 v230, v49, v133
    v_mfma_f32_16x16x32_bf16 v[40:43], v[120:123], v[20:23], 0
    buffer_store_dwordx3 v[96:98], v197, s[16:19], s34 offen offset:768 sc1 nt
    v_mfma_f32_16x16x32_bf16 v[40:43], v[200:203], v[56:59], v[40:43]
    s_add_u32 s34, s34, 9144576
    v_cvt_pk_bf16_f32 v46, v50, v134
    v_cvt_pk_bf16_f32 v74, v51, v135
    v_mfma_f32_16x16x32_bf16 v[40:43], v[104:107], v[32:35], v[40:43]
    v_exp_f32 v224, v224
    v_mfma_f32_16x16x32_bf16 v[152:155], v[80:83], v[20:23], 0
    v_exp_f32 v225, v225
    v_mfma_f32_16x16x32_bf16 v[152:155], v[36:39], v[56:59], v[152:155]
    buffer_store_dwordx3 v[228:230], v178, s[16:19], s35 offen offset:192 sc1 nt
    v_mfma_f32_16x16x32_bf16 v[152:155], v[52:55], v[32:35], v[152:155]
    v_exp_f32 v226, v226
    v_mfma_f32_16x16x32_bf16 v[112:115], v[180:183], v[28:31], 0
    s_waitcnt lgkmcnt(0)
    v_exp_f32 v227, v227
    v_mfma_f32_16x16x32_bf16 v[112:115], v[180:183], v[184:187], v[112:115]
    v_exp_f32 v40, v40
    v_mfma_f32_16x16x32_bf16 v[220:223], a[192:195], v[28:31], 0
    v_exp_f32 v41, v41
    v_mfma_f32_16x16x32_bf16 v[220:223], a[220:223], v[184:187], v[220:223]
    v_exp_f32 v152, v152
    v_mfma_f32_16x16x32_bf16 v[128:131], a[224:227], v[28:31], 0
    buffer_store_dwordx3 v[44:46], v179, s[16:19], s35 offen offset:960 sc1 nt
    v_mfma_f32_16x16x32_bf16 v[128:131], a[228:231], v[184:187], v[128:131]
    s_add_u32 s35, s35, 9144576
    v_exp_f32 v153, v153
    v_mfma_f32_16x16x32_bf16 v[156:159], a[196:199], v[28:31], 0
    v_exp_f32 v154, v154
    v_mfma_f32_16x16x32_bf16 v[156:159], a[200:203], v[184:187], v[156:159]
    v_exp_f32 v155, v155
    v_mfma_f32_16x16x32_bf16 v[216:219], a[204:207], v[28:31], 0
    v_cvt_pk_bf16_f32 v188, v152, v153
    v_cvt_pk_bf16_f32 v189, v154, v155
    v_mfma_f32_16x16x32_bf16 v[216:219], a[208:211], v[184:187], v[216:219]
    v_rcp_f32 v13, v112
    v_mfma_f32_16x16x32_bf16 v[232:235], a[212:215], v[28:31], 0
    buffer_store_dwordx3 v[72:74], v178, s[16:19], s36 offen offset:384 sc1 nt
    v_mfma_f32_16x16x32_bf16 v[232:235], a[216:219], v[184:187], v[232:235]
    s_add_u32 s36, s36, 9144576
    v_mul_f32 v220, v220, v13
    v_mul_f32 v128, v128, v13
    v_mfma_f32_16x16x32_bf16 v[212:215], a[232:235], v[28:31], 0
    v_mul_f32 v221, v221, v13
    v_mul_f32 v129, v129, v13
    v_mfma_f32_16x16x32_bf16 v[212:215], a[244:247], v[184:187], v[212:215]
    v_mul_f32 v222, v222, v13
    v_mul_f32 v130, v130, v13
    v_mfma_f32_16x16x32_bf16 v[100:103], a[0:3], v[80:83], 0
    v_mul_f32 v223, v223, v13
    v_mul_f32 v131, v131, v13
    v_mfma_f32_16x16x32_bf16 v[100:103], a[4:7], v[36:39], v[100:103]
    v_cvt_pk_bf16_f32 v108, v220, v128
    v_cvt_pk_bf16_f32 v109, v221, v129
    v_mfma_f32_16x16x32_bf16 v[100:103], a[8:11], v[52:55], v[100:103]
    v_cvt_pk_bf16_f32 v110, v222, v130
    v_cvt_pk_bf16_f32 v111, v223, v131
    v_mfma_f32_16x16x32_bf16 v[76:79], a[12:15], v[80:83], 0
    v_mul_f32 v156, v156, v13
    v_mul_f32 v216, v216, v13
    v_mfma_f32_16x16x32_bf16 v[76:79], a[16:19], v[36:39], v[76:79]
    v_mul_f32 v157, v157, v13
    v_mul_f32 v217, v217, v13
    v_mfma_f32_16x16x32_bf16 v[76:79], a[20:23], v[52:55], v[76:79]
    v_cvt_pk_bf16_f32 v92, v100, v101
    v_cvt_pk_bf16_f32 v93, v102, v103
    v_mfma_f32_16x16x32_bf16 v[204:207], a[24:27], v[80:83], 0
    v_mul_f32 v158, v158, v13
    v_mul_f32 v218, v218, v13
    v_mfma_f32_16x16x32_bf16 v[204:207], a[28:31], v[36:39], v[204:207]
    v_mul_f32 v159, v159, v13
    v_mul_f32 v219, v219, v13
    v_mfma_f32_16x16x32_bf16 v[204:207], a[32:35], v[52:55], v[204:207]
    v_cvt_pk_bf16_f32 v160, v156, v216
    v_cvt_pk_bf16_f32 v161, v157, v217
    v_mfma_f32_16x16x32_bf16 v[164:167], a[36:39], v[80:83], 0
    v_cvt_pk_bf16_f32 v162, v158, v218
    v_cvt_pk_bf16_f32 v163, v159, v219
    v_mfma_f32_16x16x32_bf16 v[164:167], a[40:43], v[36:39], v[164:167]
    v_mul_f32 v232, v232, v13
    v_mul_f32 v212, v212, v13
    v_mfma_f32_16x16x32_bf16 v[164:167], a[44:47], v[52:55], v[164:167]
    v_mul_f32 v233, v233, v13
    v_mul_f32 v213, v213, v13
    v_mfma_f32_16x16x32_bf16 v[88:91], a[48:51], v[80:83], 0
    v_mul_f32 v234, v234, v13
    v_mul_f32 v214, v214, v13
    v_mfma_f32_16x16x32_bf16 v[88:91], a[52:55], v[36:39], v[88:91]
    v_mul_f32 v235, v235, v13
    v_mul_f32 v215, v215, v13
    v_mfma_f32_16x16x32_bf16 v[88:91], a[56:59], v[52:55], v[88:91]
    v_cvt_pk_bf16_f32 v236, v232, v212
    v_cvt_pk_bf16_f32 v237, v233, v213
    v_mfma_f32_16x16x32_bf16 v[208:211], a[60:63], v[80:83], 0
    v_cvt_pk_bf16_f32 v238, v234, v214
    v_cvt_pk_bf16_f32 v239, v235, v215
    v_mfma_f32_16x16x32_bf16 v[208:211], a[64:67], v[36:39], v[208:211]
    v_cvt_pk_bf16_f32 v94, v76, v77
    v_cvt_pk_bf16_f32 v95, v78, v79
    v_mfma_f32_16x16x32_bf16 v[208:211], a[68:71], v[52:55], v[208:211]
    v_cvt_pk_bf16_f32 v84, v204, v205
    v_cvt_pk_bf16_f32 v85, v206, v207
    v_mfma_f32_16x16x32_bf16 v[140:143], v[108:111], a[72:75], 0
    v_cvt_pk_bf16_f32 v86, v164, v165
    v_cvt_pk_bf16_f32 v87, v166, v167
    v_mfma_f32_16x16x32_bf16 v[140:143], v[160:163], a[76:79], v[140:143]
    v_cvt_pk_bf16_f32 v68, v88, v89
    v_cvt_pk_bf16_f32 v69, v90, v91
    v_mfma_f32_16x16x32_bf16 v[140:143], v[236:239], a[80:83], v[140:143]
    v_cvt_pk_bf16_f32 v70, v208, v209
    v_cvt_pk_bf16_f32 v71, v210, v211
    v_mfma_f32_16x16x32_bf16 v[124:127], v[108:111], a[84:87], 0
    v_exp_f32 v42, v42
    v_mfma_f32_16x16x32_bf16 v[124:127], v[160:163], a[88:91], v[124:127]
    v_exp_f32 v43, v43
    v_mfma_f32_16x16x32_bf16 v[124:127], v[236:239], a[92:95], v[124:127]
    v_cvt_pk_bf16_f32 v24, v224, v225
    v_cvt_pk_bf16_f32 v25, v226, v227
    v_mfma_f32_16x16x32_bf16 v[148:151], v[108:111], a[96:99], 0
    v_cvt_pk_bf16_f32 v26, v40, v41
    v_cvt_pk_bf16_f32 v27, v42, v43
    v_mfma_f32_16x16x32_bf16 v[148:151], v[160:163], a[100:103], v[148:151]
    v_mfma_f32_16x16x32_bf16 v[148:151], v[236:239], a[104:107], v[148:151]
    v_mfma_f32_16x16x32_bf16 v[96:99], v[108:111], a[108:111], 0
    v_cvt_pk_bf16_f32 v48, v140, v124
    v_cvt_pk_bf16_f32 v132, v141, v125
    v_mfma_f32_16x16x32_bf16 v[96:99], v[160:163], a[112:115], v[96:99]
    v_cvt_pk_bf16_f32 v228, v142, v126
    v_cvt_pk_bf16_f32 v20, v143, v127
    v_mfma_f32_16x16x32_bf16 v[96:99], v[236:239], a[116:119], v[96:99]
    v_mfma_f32_16x16x32_bf16 v[56:59], v[108:111], a[124:127], 0
    v_mfma_f32_16x16x32_bf16 v[56:59], v[160:163], a[120:123], v[56:59]
    ds_read_b128 v[32:35], v170 offset:6464
    v_mfma_f32_16x16x32_bf16 v[56:59], v[236:239], a[128:131], v[56:59]
    v_mfma_f32_16x16x32_bf16 v[44:47], v[108:111], a[132:135], 0
    v_mfma_f32_16x16x32_bf16 v[44:47], v[160:163], a[136:139], v[44:47]
    v_mfma_f32_16x16x32_bf16 v[44:47], v[236:239], a[140:143], v[44:47]
    v_mfma_f32_16x16x32_bf16 v[152:155], v[16:19], v[92:95], 0
    v_cvt_pk_bf16_f32 v49, v148, v96
    v_cvt_pk_bf16_f32 v133, v149, v97
    v_mfma_f32_16x16x32_bf16 v[152:155], v[144:147], v[84:87], v[152:155]
    v_cvt_pk_bf16_f32 v229, v150, v98
    v_cvt_pk_bf16_f32 v21, v151, v99
    v_mfma_f32_16x16x32_bf16 v[152:155], v[64:67], v[68:71], v[152:155]
    s_waitcnt lgkmcnt(0)
    v_add_f32 v32, v32, v33
    v_cvt_pk_bf16_f32 v50, v56, v44
    v_mfma_f32_16x16x32_bf16 v[112:115], v[120:123], v[92:95], 0
    buffer_store_dwordx3 v[48:50], v178, s[16:19], s30 offen offset:0 sc1 nt
    v_mfma_f32_16x16x32_bf16 v[112:115], v[200:203], v[84:87], v[112:115]
    v_cvt_pk_bf16_f32 v134, v57, v45
    v_add_f32 v32, v32, v34
    v_mfma_f32_16x16x32_bf16 v[112:115], v[104:107], v[68:71], v[112:115]
    v_cndmask_b32 v176, v177, v32, s[56:57]
    v_cvt_pk_bf16_f32 v230, v58, v46
    v_mfma_f32_16x16x32_bf16 v[72:75], v[80:83], v[92:95], 0
    v_cvt_pk_bf16_f32 v22, v59, v47
    v_cndmask_b32 v176, v176, v117, s[50:51]
    v_mfma_f32_16x16x32_bf16 v[72:75], v[36:39], v[84:87], v[72:75]
    buffer_store_dwordx3 v[132:134], v197, s[16:19], s30 offen offset:768 sc1 nt
    v_mfma_f32_16x16x32_bf16 v[72:75], v[52:55], v[68:71], v[72:75]
    v_cndmask_b32 v176, v176, v61, s[52:53]
    v_cndmask_b32 v176, v176, v137, s[54:55]
    v_mfma_f32_16x16x32_bf16 v[28:31], v[180:183], v[24:27], 0
    v_exp_f32 v176, v176
    v_mfma_f32_16x16x32_bf16 v[28:31], v[180:183], v[188:191], v[28:31]
    v_cvt_pk_bf16_f32 v176, v176, v176
    v_mfma_f32_16x16x32_bf16 v[184:187], a[192:195], v[24:27], 0
    ds_write_b16 v171, v176 offset:576
    v_mfma_f32_16x16x32_bf16 v[184:187], a[220:223], v[188:191], v[184:187]
    ds_read2_b64 v[128:131], v172 offset0:72 offset1:76
    v_exp_f32 v72, v72
    v_mfma_f32_16x16x32_bf16 v[220:223], a[224:227], v[24:27], 0
    buffer_store_dwordx3 v[228:230], v178, s[16:19], s31 offen offset:192 sc1 nt
    v_mfma_f32_16x16x32_bf16 v[220:223], a[228:231], v[188:191], v[220:223]
    ds_read2_b64 v[100:103], v172 offset0:80 offset1:84
    v_exp_f32 v73, v73
    v_mfma_f32_16x16x32_bf16 v[156:159], a[196:199], v[24:27], 0
    v_exp_f32 v74, v74
    v_mfma_f32_16x16x32_bf16 v[156:159], a[200:203], v[188:191], v[156:159]
    v_exp_f32 v75, v75
    v_mfma_f32_16x16x32_bf16 v[216:219], a[204:207], v[24:27], 0
    v_cvt_pk_bf16_f32 v192, v72, v73
    v_cvt_pk_bf16_f32 v193, v74, v75
    v_mfma_f32_16x16x32_bf16 v[216:219], a[208:211], v[188:191], v[216:219]
    v_rcp_f32 v176, v28
    v_mfma_f32_16x16x32_bf16 v[212:215], a[212:215], v[24:27], 0
    buffer_store_dwordx3 v[20:22], v179, s[16:19], s31 offen offset:960 sc1 nt
    v_mfma_f32_16x16x32_bf16 v[212:215], a[216:219], v[188:191], v[212:215]
    v_mul_f32 v184, v184, v176
    v_mul_f32 v220, v220, v176
    v_mfma_f32_16x16x32_bf16 v[232:235], a[232:235], v[24:27], 0
    s_waitcnt lgkmcnt(0)
    v_mul_f32 v185, v185, v176
    v_mul_f32 v221, v221, v176
    v_mfma_f32_16x16x32_bf16 v[232:235], a[244:247], v[188:191], v[232:235]
    v_mul_f32 v186, v186, v176
    v_mul_f32 v222, v222, v176
    v_mfma_f32_16x16x32_bf16 v[76:79], v[128:131], v[180:183], 0
    v_mul_f32 v187, v187, v176
    v_mul_f32 v223, v223, v176
    v_mfma_f32_16x16x32_bf16 v[76:79], v[100:103], v[180:183], v[76:79]
    v_cvt_pk_bf16_f32 v204, v184, v220
    v_cvt_pk_bf16_f32 v205, v185, v221
    v_mfma_f32_16x16x32_bf16 v[164:167], v[128:131], a[192:195], 0
L_h3:
    s_cbranch_execz L_hopret
    v_cvt_pk_bf16_f32 v206, v186, v222
    v_cvt_pk_bf16_f32 v207, v187, v223
    v_mfma_f32_16x16x32_bf16 v[164:167], v[100:103], a[220:223], v[164:167]
    v_mul_f32 v156, v156, v176
    v_mul_f32 v216, v216, v176
    v_mfma_f32_16x16x32_bf16 v[88:91], v[128:131], a[224:227], 0
    v_mul_f32 v157, v157, v176
    v_mul_f32 v217, v217, v176
    v_mfma_f32_16x16x32_bf16 v[88:91], v[100:103], a[228:231], v[88:91]
    v_mul_f32 v158, v158, v176
    v_mul_f32 v218, v218, v176
    v_mfma_f32_16x16x32_bf16 v[208:211], v[128:131], a[196:199], 0
    v_mul_f32 v159, v159, v176
    v_mul_f32 v219, v219, v176
    v_mfma_f32_16x16x32_bf16 v[208:211], v[100:103], a[200:203], v[208:211]
    v_cvt_pk_bf16_f32 v224, v156, v216
    v_cvt_pk_bf16_f32 v225, v157, v217
    v_mfma_f32_16x16x32_bf16 v[40:43], v[128:131], a[204:207], 0
    v_cvt_pk_bf16_f32 v226, v158, v218
    v_cvt_pk_bf16_f32 v227, v159, v219
    v_mfma_f32_16x16x32_bf16 v[40:43], v[100:103], a[208:211], v[40:43]
    v_mul_f32 v212, v212, v176
    v_mul_f32 v232, v232, v176
    v_mfma_f32_16x16x32_bf16 v[124:127], v[128:131], a[212:215], 0
    v_mul_f32 v213, v213, v176
    v_mul_f32 v233, v233, v176
    v_mfma_f32_16x16x32_bf16 v[124:127], v[100:103], a[216:219], v[124:127]
    v_mul_f32 v214, v214, v176
    v_mul_f32 v234, v234, v176
    v_mfma_f32_16x16x32_bf16 v[140:143], v[128:131], a[232:235], 0
    v_mul_f32 v215, v215, v176
    v_mul_f32 v235, v235, v176
    v_mfma_f32_16x16x32_bf16 v[140:143], v[100:103], a[244:247], v[140:143]
    v_cndmask_b32 v169, v169, v76, s[54:55]
    v_cvt_pk_bf16_f32 v108, v212, v232
    v_mfma_f32_16x16x32_bf16 v[160:163], v[204:207], a[72:75], 0
    v_cvt_pk_bf16_f32 v109, v213, v233
    v_cvt_pk_bf16_f32 v110, v214, v234
    v_mfma_f32_16x16x32_bf16 v[160:163], v[224:227], a[76:79], v[160:163]
    v_cvt_pk_bf16_f32 v111, v215, v235
    v_cvt_pk_bf16_f32 v177, v164, v88
    ds_write_b32 v173, v177 offset:6144
    v_mfma_f32_16x16x32_bf16 v[160:163], v[108:111], a[80:83], v[160:163]
    v_cvt_pk_bf16_f32 v177, v208, v40
    v_cvt_pk_bf16_f32 v198, v124, v140
    v_mfma_f32_16x16x32_bf16 v[96:99], v[204:207], a[84:87], 0
    ds_write_b32 v173, v177 offset:6208
    v_mfma_f32_16x16x32_bf16 v[96:99], v[224:227], a[88:91], v[96:99]
    ds_write_b32 v173, v198 offset:6272
    v_mfma_f32_16x16x32_bf16 v[96:99], v[108:111], a[92:95], v[96:99]
    v_exp_f32 v152, v152
    v_mfma_f32_16x16x32_bf16 v[148:151], v[204:207], a[96:99], 0
    v_exp_f32 v153, v153
    v_mfma_f32_16x16x32_bf16 v[148:151], v[224:227], a[100:103], v[148:151]
    v_exp_f32 v154, v154
    v_mfma_f32_16x16x32_bf16 v[148:151], v[108:111], a[104:107], v[148:151]
    v_exp_f32 v155, v155
    v_mfma_f32_16x16x32_bf16 v[236:239], v[204:207], a[108:111], 0
    v_exp_f32 v112, v112
    v_mfma_f32_16x16x32_bf16 v[236:239], v[224:227], a[112:115], v[236:239]
    v_exp_f32 v113, v113
    v_mfma_f32_16x16x32_bf16 v[236:239], v[108:111], a[116:119], v[236:239]
    v_exp_f32 v114, v114
    v_mfma_f32_16x16x32_bf16 v[16:19], v[204:207], a[124:127], 0
    v_exp_f32 v115, v115
    v_mfma_f32_16x16x32_bf16 v[16:19], v[224:227], a[120:123], v[16:19]
    v_cvt_pk_bf16_f32 v144, v152, v153
    v_cvt_pk_bf16_f32 v145, v154, v155
    v_mfma_f32_16x16x32_bf16 v[16:19], v[108:111], a[128:131], v[16:19]
    ds_read_b128 v[48:51], v14 offset:384
    v_cvt_pk_bf16_f32 v146, v112, v113
    v_mfma_f32_16x16x32_bf16 v[64:67], v[204:207], a[132:135], 0
    ds_read_b128 v[32:35], v14 offset:448
    v_cvt_pk_bf16_f32 v147, v114, v115
    v_mfma_f32_16x16x32_bf16 v[64:67], v[224:227], a[136:139], v[64:67]
    ds_read_b128 v[120:123], v14 offset:512
    v_cvt_pk_bf16_f32 v200, v160, v96
    v_mfma_f32_16x16x32_bf16 v[64:67], v[108:111], a[140:143], v[64:67]
    v_cvt_pk_bf16_f32 v44, v161, v97
    v_cvt_pk_bf16_f32 v56, v162, v98
    v_mfma_f32_16x16x32_bf16 v[116:119], v[180:183], v[144:147], 0
    v_cvt_pk_bf16_f32 v104, v163, v99
    v_cvt_pk_bf16_f32 v201, v148, v236
    v_mfma_f32_16x16x32_bf16 v[116:119], v[180:183], v[192:195], v[116:119]
    v_cvt_pk_bf16_f32 v45, v149, v237
    v_cvt_pk_bf16_f32 v57, v150, v238
    v_mfma_f32_16x16x32_bf16 v[132:135], a[192:195], v[144:147], 0
    v_cvt_pk_bf16_f32 v202, v16, v64
    v_cvt_pk_bf16_f32 v105, v151, v239
    v_mfma_f32_16x16x32_bf16 v[132:135], a[220:223], v[192:195], v[132:135]
    buffer_store_dwordx3 v[200:202], v178, s[16:19], s32 offen offset:384 sc1 nt
    v_mfma_f32_16x16x32_bf16 v[60:63], a[224:227], v[144:147], 0
    v_cvt_pk_bf16_f32 v46, v17, v65
    v_cvt_pk_bf16_f32 v58, v18, v66
    v_mfma_f32_16x16x32_bf16 v[60:63], a[228:231], v[192:195], v[60:63]
    v_cvt_pk_bf16_f32 v106, v19, v67
    v_rcp_f32 v14, v116
    v_mfma_f32_16x16x32_bf16 v[80:83], a[196:199], v[144:147], 0
    v_mul_f32 v132, v132, v14
    v_mul_f32 v133, v133, v14
    v_mfma_f32_16x16x32_bf16 v[80:83], a[200:203], v[192:195], v[80:83]
    buffer_store_dwordx3 v[44:46], v196, s[16:19], s32 offen offset:1152 sc1 nt
    v_mfma_f32_16x16x32_bf16 v[92:95], a[204:207], v[144:147], 0
    v_mul_f32 v60, v60, v14
    v_mul_f32 v61, v61, v14
    v_mfma_f32_16x16x32_bf16 v[92:95], a[208:211], v[192:195], v[92:95]
    v_mul_f32 v134, v134, v14
    v_mul_f32 v62, v62, v14
    v_mfma_f32_16x16x32_bf16 v[136:139], a[212:215], v[144:147], 0
    v_mul_f32 v135, v135, v14
    v_mul_f32 v63, v63, v14
    v_mfma_f32_16x16x32_bf16 v[136:139], a[216:219], v[192:195], v[136:139]
    v_cvt_pk_bf16_f32 v36, v132, v60
    v_cvt_pk_bf16_f32 v37, v133, v61
    v_mfma_f32_16x16x32_bf16 v[84:87], a[232:235], v[144:147], 0
    s_waitcnt lgkmcnt(0)
    v_cvt_pk_bf16_f32 v38, v134, v62
    v_cvt_pk_bf16_f32 v39, v135, v63
    v_mfma_f32_16x16x32_bf16 v[84:87], a[244:247], v[192:195], v[84:87]
    buffer_store_dwordx3 v[56:58], v178, s[16:19], s33 offen offset:576 sc1 nt
    v_mfma_f32_16x16x32_bf16 v[52:55], v[48:51], a[72:75], 0
    v_mul_f32 v80, v80, v14
    v_mul_f32 v92, v92, v14
    v_mfma_f32_16x16x32_bf16 v[52:55], v[32:35], a[76:79], v[52:55]
    v_mul_f32 v81, v81, v14
    v_mul_f32 v93, v93, v14
    v_mfma_f32_16x16x32_bf16 v[52:55], v[120:123], a[80:83], v[52:55]
    v_mul_f32 v82, v82, v14
    v_mul_f32 v94, v94, v14
    v_mfma_f32_16x16x32_bf16 v[68:71], v[48:51], a[84:87], 0
    v_mul_f32 v83, v83, v14
    v_mul_f32 v95, v95, v14
    v_mfma_f32_16x16x32_bf16 v[68:71], v[32:35], a[88:91], v[68:71]
    v_cvt_pk_bf16_f32 v228, v80, v92
    v_cvt_pk_bf16_f32 v229, v81, v93
    v_mfma_f32_16x16x32_bf16 v[68:71], v[120:123], a[92:95], v[68:71]
    buffer_store_dwordx3 v[104:106], v178, s[16:19], s34 offen offset:0 sc1 nt
    v_mfma_f32_16x16x32_bf16 v[72:75], v[48:51], a[96:99], 0
    v_cvt_pk_bf16_f32 v230, v82, v94
    v_cvt_pk_bf16_f32 v231, v83, v95
    v_mfma_f32_16x16x32_bf16 v[72:75], v[32:35], a[100:103], v[72:75]
    v_mul_f32 v136, v136, v14
    v_mul_f32 v84, v84, v14
    v_mfma_f32_16x16x32_bf16 v[72:75], v[120:123], a[104:107], v[72:75]
    v_mul_f32 v137, v137, v14
    v_mul_f32 v85, v85, v14
    v_mfma_f32_16x16x32_bf16 v[28:31], v[48:51], a[108:111], 0
    v_mul_f32 v138, v138, v14
    v_mul_f32 v86, v86, v14
    v_mfma_f32_16x16x32_bf16 v[28:31], v[32:35], a[112:115], v[28:31]
    v_mul_f32 v139, v139, v14
    v_mul_f32 v87, v87, v14
    v_mfma_f32_16x16x32_bf16 v[28:31], v[120:123], a[116:119], v[28:31]
    v_cvt_pk_bf16_f32 v20, v136, v84
    v_cvt_pk_bf16_f32 v21, v137, v85
    v_mfma_f32_16x16x32_bf16 v[24:27], v[48:51], a[124:127], 0
    v_cvt_pk_bf16_f32 v22, v138, v86
    v_cvt_pk_bf16_f32 v23, v139, v87
    v_mfma_f32_16x16x32_bf16 v[24:27], v[32:35], a[120:123], v[24:27]
    v_max3_u32 v177, v13, v176, v14
    v_cmp_lt_u32 vcc, 0x4b800000, v177
    v_mfma_f32_16x16x32_bf16 v[24:27], v[120:123], a[128:131], v[24:27]
    v_min3_u32 v177, v13, v176, v14
    s_or_b64 s[58:59], s[58:59], vcc
    v_mfma_f32_16x16x32_bf16 v[188:191], v[48:51], a[132:135], 0
    v_cmp_gt_u32 vcc, 0x27800000, v177
    v_rcp_f32 v13, v169
    v_mfma_f32_16x16x32_bf16 v[188:191], v[32:35], a[136:139], v[188:191]
    s_or_b64 s[58:59], s[58:59], vcc
    v_mul_f32 v52, v52, v13
    v_mul_f32 v68, v68, v13
    v_mfma_f32_16x16x32_bf16 v[188:191], v[120:123], a[140:143], v[188:191]
    v_mul_f32 v72, v72, v13
    v_mul_f32 v28, v28, v13
    v_mfma_f32_16x16x32_bf16 v[184:187], v[36:39], a[72:75], 0
    v_mul_f32 v24, v24, v13
    v_cvt_pk_bf16_f32 v220, v52, v68
    v_mfma_f32_16x16x32_bf16 v[184:187], v[228:231], a[76:79], v[184:187]
    v_cvt_pk_bf16_f32 v221, v72, v28
    v_cmp_lt_u32 vcc, 0x4b800000, v13
    v_mfma_f32_16x16x32_bf16 v[184:187], v[20:23], a[80:83], v[184:187]
    v_mul_f32 v188, v188, v13
    v_cvt_pk_bf16_f32 v222, v24, v188
    v_mfma_f32_16x16x32_bf16 v[156:159], v[36:39], a[84:87], 0
    s_or_b64 s[58:59], s[58:59], vcc
    v_cmp_gt_u32 vcc, 0x27800000, v13
    v_mfma_f32_16x16x32_bf16 v[156:159], v[228:231], a[88:91], v[156:159]
    v_mfma_f32_16x16x32_bf16 v[156:159], v[20:23], a[92:95], v[156:159]
    buffer_store_dwordx3 v[220:222], v15, s[16:19], s61 offen sc1 nt
    v_mfma_f32_16x16x32_bf16 v[216:219], v[36:39], a[96:99], 0
    s_or_b64 s[58:59], s[58:59], vcc
    v_mfma_f32_16x16x32_bf16 v[216:219], v[228:231], a[100:103], v[216:219]
    v_mfma_f32_16x16x32_bf16 v[216:219], v[20:23], a[104:107], v[216:219]
    v_mfma_f32_16x16x32_bf16 v[76:79], v[36:39], a[108:111], 0
    v_mfma_f32_16x16x32_bf16 v[76:79], v[228:231], a[112:115], v[76:79]
    v_mfma_f32_16x16x32_bf16 v[76:79], v[20:23], a[116:119], v[76:79]
    v_cvt_pk_bf16_f32 v128, v184, v156
    v_cvt_pk_bf16_f32 v100, v185, v157
    v_mfma_f32_16x16x32_bf16 v[212:215], v[36:39], a[124:127], 0
    v_cvt_pk_bf16_f32 v232, v186, v158
    v_cvt_pk_bf16_f32 v88, v187, v159
    v_mfma_f32_16x16x32_bf16 v[212:215], v[228:231], a[120:123], v[212:215]
    v_mfma_f32_16x16x32_bf16 v[212:215], v[20:23], a[128:131], v[212:215]
    v_mfma_f32_16x16x32_bf16 v[164:167], v[36:39], a[132:135], 0
    v_cvt_pk_bf16_f32 v129, v216, v76
    v_cvt_pk_bf16_f32 v101, v217, v77
    v_mfma_f32_16x16x32_bf16 v[164:167], v[228:231], a[136:139], v[164:167]
    v_cvt_pk_bf16_f32 v233, v218, v78
    v_cvt_pk_bf16_f32 v89, v219, v79
    v_mfma_f32_16x16x32_bf16 v[164:167], v[20:23], a[140:143], v[164:167]
    s_nop 7
    v_cvt_pk_bf16_f32 v130, v212, v164
    v_cvt_pk_bf16_f32 v102, v213, v165
    v_cvt_pk_bf16_f32 v234, v214, v166
    v_cvt_pk_bf16_f32 v90, v215, v167
    buffer_store_dwordx3 v[128:130], v197, s[16:19], s34 offen offset:768 sc1 nt
    buffer_store_dwordx3 v[100:102], v178, s[16:19], s35 offen offset:192 sc1 nt
    buffer_store_dwordx3 v[232:234], v179, s[16:19], s35 offen offset:960 sc1 nt
    buffer_store_dwordx3 v[88:90], v178, s[16:19], s36 offen offset:384 sc1 nt
L_mainend:
    s_cmp_lg_u64 s[58:59], 0
    s_cbranch_scc1 L_slow
L_done:
    s_endpgm
L_fin:
L_slow:
    s_mov_b32 s63, 0
    s_mov_b32 s30, s37
L_slow1:
    s_waitcnt vmcnt(0) lgkmcnt(0)
    s_nop 7
    v_lshrrev_b32 v21, 2, v0
    v_bitop3_b32 v21, v21, 8, v0 bitop3:0x6a
    v_lshlrev_b32 v1, 4, v21
    v_lshrrev_b32 v20, 4, v0
    s_movk_i32 s40, 192
    v_and_b32 v21, 3, v0
    v_bfe_u32 v22, v0, 2, 2
    v_lshl_add_u32 v22, v21, 2, v22
    v_xor_b32 v2, v20, v21
    v_lshl_add_u32 v2, v2, 4, s60
    v_mad_u32_u24 v2, v22, s40, v2
    v_lshrrev_b32 v1, 4, v0
    s_movk_i32 s40, 192
    v_lshl_add_u32 v3, v1, 4, s38
    v_and_b32 v4, 1, v0
    v_mad_u32_u24 v3, v4, s40, v3
    ds_read_b128 v[8:11], v2 offset:0
    ds_read_b128 v[12:15], v3 offset:0
    ds_read_b128 v[16:19], v2 offset:64
    ds_read_b128 v[20:23], v3 offset:64
    ds_read_b128 v[24:27], v2 offset:128
    ds_read_b128 v[28:31], v3 offset:128
    ds_read_b128 v[32:35], v2 offset:3072
    ds_read_b128 v[36:39], v2 offset:3136
    ds_read_b128 v[40:43], v2 offset:3200
    ds_read_b128 v[44:47], v2 offset:6144
    ds_read_b128 v[48:51], v2 offset:6208
    ds_read_b128 v[52:55], v2 offset:6272
    v_bfe_u32 v2, v0, 2, 2
    v_and_b32 v3, 3, v0
    v_lshlrev_b32 v4, 1, v2
    v_mul_u32_u24 v5, 12, v0
    s_waitcnt lgkmcnt(10)
    v_mfma_f32_16x16x32_bf16 v[56:59], v[12:15], v[8:11], 0
    s_waitcnt lgkmcnt(8)
    v_xor_b32 v4, v4, v3
    v_mfma_f32_16x16x32_bf16 v[56:59], v[20:23], v[16:19], v[56:59]
    s_waitcnt lgkmcnt(6)
    v_add_u32 v6, 0x11640, v5
    v_mfma_f32_16x16x32_bf16 v[56:59], v[28:31], v[24:27], v[56:59]
    s_waitcnt lgkmcnt(5)
    s_mov_b64 s[50:51], 0xffff
    v_lshl_add_u32 v7, v4, 3, s60
    v_mfma_f32_16x16x32_bf16 v[60:63], v[12:15], v[32:35], 0
    s_waitcnt lgkmcnt(3)
    v_lshl_add_u32 v4, v2, 2, v1
    v_mov_b32 v2, 0xff800000
    v_mfma_f32_16x16x32_bf16 v[60:63], v[20:23], v[36:39], v[60:63]
    s_waitcnt lgkmcnt(1)
    s_lshl_b64 s[52:53], s[50:51], 16
    v_cndmask_b32 v64, v6, v5, s[50:51]
    v_mfma_f32_16x16x32_bf16 v[60:63], v[28:31], v[40:43], v[60:63]
    s_lshl_b64 s[54:55], s[50:51], 32
    v_mad_u32_u24 v7, v4, s40, v7
    v_and_b32 v4, 15, v0
    v_mfma_f32_16x16x32_bf16 v[68:71], v[12:15], v[44:47], 0
    s_waitcnt lgkmcnt(0)
    v_cndmask_b32 v6, v64, v5, s[52:53]
    v_cndmask_b32 v65, v2, v56, s[50:51]
    v_mfma_f32_16x16x32_bf16 v[68:71], v[20:23], v[48:51], v[68:71]
    s_lshl_b64 s[56:57], 1, 48
    v_lshl_add_u32 v66, v3, 3, s39
    v_xor_b32 v3, 32, v7
    v_mfma_f32_16x16x32_bf16 v[68:71], v[28:31], v[52:55], v[68:71]
    s_add_u32 s31, s30, 72576
    v_mov_b32 v67, s38
    v_lshl_add_u32 v12, v0, 1, s38
    v_mfma_f32_16x16x32_bf16 v[72:75], a[0:3], v[8:11], 0
    s_add_u32 s32, s30, 145152
    v_lshl_add_u32 v13, v1, 3, s38
    v_lshl_add_u32 v1, v4, 2, s38
    v_mfma_f32_16x16x32_bf16 v[72:75], a[4:7], v[16:19], v[72:75]
    s_add_u32 s33, s30, 217728
    v_mov_b32 v76, 0x3f803f80
    v_mov_b32 v77, 0x3f803f80
    v_mfma_f32_16x16x32_bf16 v[72:75], a[8:11], v[24:27], v[72:75]
    s_add_u32 s34, s30, 290304
    v_mov_b32 v78, 0x3f803f80
    v_mov_b32 v79, 0x3f803f80
    v_mfma_f32_16x16x32_bf16 v[80:83], a[12:15], v[8:11], 0
    s_add_u32 s35, s30, 362880
    v_mov_b32 v87, 0
    v_mov_b32 v91, 0
    v_mfma_f32_16x16x32_bf16 v[80:83], a[16:19], v[16:19], v[80:83]
    s_add_u32 s36, s30, 435456
    v_cvt_pk_bf16_f32 v92, v72, v73
    v_cvt_pk_bf16_f32 v93, v74, v75
    v_mfma_f32_16x16x32_bf16 v[80:83], a[20:23], v[24:27], v[80:83]
    ds_read_b64_tr_b16 a[144:145], v7 offset:0
    v_mov_b32 v99, 0
    v_mfma_f32_16x16x32_bf16 v[100:103], a[24:27], v[8:11], 0
    ds_read_b64_tr_b16 a[146:147], v7 offset:3072
    v_cndmask_b32 v4, v6, v5, s[54:55]
    v_mfma_f32_16x16x32_bf16 v[100:103], a[28:31], v[16:19], v[100:103]
    ds_read_b64_tr_b16 a[148:149], v7 offset:6144
    v_and_b32 v14, 48, v0
    v_mfma_f32_16x16x32_bf16 v[100:103], a[32:35], v[24:27], v[100:103]
    ds_read_b64_tr_b16 a[150:151], v66 offset:0
    v_cvt_pk_bf16_f32 v94, v80, v81
    v_mfma_f32_16x16x32_bf16 v[104:107], a[36:39], v[8:11], 0
    ds_read_b64_tr_b16 a[152:153], v3 offset:0
    v_cvt_pk_bf16_f32 v95, v82, v83
    v_mfma_f32_16x16x32_bf16 v[104:107], a[40:43], v[16:19], v[104:107]
    ds_read_b64_tr_b16 a[154:155], v3 offset:3072
    s_mov_b32 s62, 1714608
    v_mfma_f32_16x16x32_bf16 v[104:107], a[44:47], v[24:27], v[104:107]
    ds_read_b64_tr_b16 a[156:157], v3 offset:6144
    v_cvt_pk_bf16_f32 v108, v100, v101
    v_mfma_f32_16x16x32_bf16 v[112:115], a[48:51], v[8:11], 0
    ds_read_b64_tr_b16 a[158:159], v66 offset:32
    v_cvt_pk_bf16_f32 v109, v102, v103
    v_mfma_f32_16x16x32_bf16 v[112:115], a[52:55], v[16:19], v[112:115]
    ds_read_b64_tr_b16 a[160:161], v7 offset:64
    v_add_u32 v15, s38, v14
    v_mfma_f32_16x16x32_bf16 v[112:115], a[56:59], v[24:27], v[112:115]
    ds_read_b64_tr_b16 a[162:163], v7 offset:3136
    v_cvt_pk_bf16_f32 v110, v104, v105
    v_mfma_f32_16x16x32_bf16 v[116:119], a[60:63], v[8:11], 0
    ds_read_b64_tr_b16 a[164:165], v7 offset:6208
    v_cvt_pk_bf16_f32 v111, v106, v107
    v_mfma_f32_16x16x32_bf16 v[116:119], a[64:67], v[16:19], v[116:119]
    ds_read_b64_tr_b16 a[166:167], v66 offset:64
    v_mad_u32_u24 v20, v14, s62, v5
    v_mfma_f32_16x16x32_bf16 v[116:119], a[68:71], v[24:27], v[116:119]
    ds_read_b64_tr_b16 a[168:169], v3 offset:64
    v_cvt_pk_bf16_f32 v120, v112, v113
    v_mfma_f32_16x16x32_bf16 v[124:127], v[8:11], v[92:95], 0
    ds_read_b64_tr_b16 a[170:171], v3 offset:3136
    v_cvt_pk_bf16_f32 v121, v114, v115
    v_mfma_f32_16x16x32_bf16 v[124:127], v[16:19], v[108:111], v[124:127]
    ds_read_b64_tr_b16 a[172:173], v3 offset:6208
    ds_read_b64_tr_b16 a[174:175], v66 offset:96
    v_cvt_pk_bf16_f32 v122, v116, v117
    v_cvt_pk_bf16_f32 v123, v118, v119
    ds_read_b64_tr_b16 a[176:177], v7 offset:128
    ds_read_b64_tr_b16 a[178:179], v7 offset:3200
    v_mfma_f32_16x16x32_bf16 v[124:127], v[24:27], v[120:123], v[124:127]
    ds_read_b64_tr_b16 a[180:181], v7 offset:6272
    v_cndmask_b32 v7, v2, v60, s[50:51]
    v_mfma_f32_16x16x32_bf16 v[128:131], v[32:35], v[92:95], 0
    ds_read_b64_tr_b16 a[182:183], v66 offset:128
    v_cndmask_b32 v14, v2, v68, s[50:51]
    v_mfma_f32_16x16x32_bf16 v[128:131], v[36:39], v[108:111], v[128:131]
    ds_read_b64_tr_b16 a[184:185], v3 offset:128
    v_mfma_f32_16x16x32_bf16 v[128:131], v[40:43], v[120:123], v[128:131]
    ds_read_b64_tr_b16 a[186:187], v3 offset:3200
    v_max3_f32 v21, v65, v124, v125
    v_mfma_f32_16x16x32_bf16 v[132:135], v[44:47], v[92:95], 0
    ds_read_b64_tr_b16 a[188:189], v3 offset:6272
    v_max3_f32 v21, v21, v126, v127
    v_mfma_f32_16x16x32_bf16 v[132:135], v[48:51], v[108:111], v[132:135]
    ds_read_b64_tr_b16 a[190:191], v66 offset:160
    v_mfma_f32_16x16x32_bf16 v[132:135], v[52:55], v[120:123], v[132:135]
    v_max3_f32 v21, v21, v128, v129
    v_max3_f32 v21, v21, v130, v131
    s_nop 5
    v_max3_f32 v21, v21, v132, v133
    v_max3_f32 v21, v21, v134, v135
    v_mov_b32 v3, v21
    s_nop 1
    v_permlane32_swap_b32 v21, v3
    v_max_f32 v21, v21, v3
    v_mov_b32 v3, v21
    s_nop 1
    v_permlane16_swap_b32 v21, v3
    v_max_f32 v21, v21, v3
    v_sub_f32 v124, v124, v21
    v_sub_f32 v125, v125, v21
    v_sub_f32 v126, v126, v21
    v_sub_f32 v127, v127, v21
    v_sub_f32 v128, v128, v21
    v_sub_f32 v129, v129, v21
    v_sub_f32 v130, v130, v21
    v_sub_f32 v131, v131, v21
    v_exp_f32 v124, v124
    v_exp_f32 v125, v125
    v_exp_f32 v126, v126
    v_exp_f32 v127, v127
    v_exp_f32 v128, v128
    v_exp_f32 v129, v129
    v_exp_f32 v130, v130
    v_exp_f32 v131, v131
    v_cvt_pk_bf16_f32 v136, v124, v125
    v_cvt_pk_bf16_f32 v137, v126, v127
    v_cvt_pk_bf16_f32 v138, v128, v129
    v_cvt_pk_bf16_f32 v139, v130, v131
    v_sub_f32 v132, v132, v21
    v_sub_f32 v133, v133, v21
    v_mfma_f32_16x16x32_bf16 v[140:143], v[76:79], v[136:139], 0
    s_waitcnt lgkmcnt(0)
    v_sub_f32 v134, v134, v21
    v_sub_f32 v135, v135, v21
    v_sub_f32 v65, v65, v21
    v_exp_f32 v132, v132
    v_exp_f32 v133, v133
    v_exp_f32 v134, v134
    v_exp_f32 v135, v135
    v_exp_f32 v65, v65
    v_cvt_pk_bf16_f32 v84, v132, v133
    v_cvt_pk_bf16_f32 v85, v134, v135
    v_cvt_pk_bf16_f32 v86, v65, 0
    s_nop 1
    v_mfma_f32_16x16x32_bf16 v[140:143], v[76:79], v[84:87], v[140:143]
    v_mfma_f32_16x16x32_bf16 v[144:147], a[144:147], v[136:139], 0
    v_mfma_f32_16x16x32_bf16 v[144:147], a[148:151], v[84:87], v[144:147]
    v_mfma_f32_16x16x32_bf16 v[148:151], a[152:155], v[136:139], 0
    v_mfma_f32_16x16x32_bf16 v[148:151], a[156:159], v[84:87], v[148:151]
    v_mfma_f32_16x16x32_bf16 v[152:155], a[160:163], v[136:139], 0
    v_mfma_f32_16x16x32_bf16 v[152:155], a[164:167], v[84:87], v[152:155]
    v_mfma_f32_16x16x32_bf16 v[156:159], a[168:171], v[136:139], 0
    v_mfma_f32_16x16x32_bf16 v[156:159], a[172:175], v[84:87], v[156:159]
    v_rcp_f32 v3, v140
    v_mfma_f32_16x16x32_bf16 v[160:163], a[176:179], v[136:139], 0
    v_mul_f32 v144, v144, v3
    v_mul_f32 v145, v145, v3
    v_mfma_f32_16x16x32_bf16 v[160:163], a[180:183], v[84:87], v[160:163]
    v_mul_f32 v148, v148, v3
    v_mul_f32 v149, v149, v3
    v_mfma_f32_16x16x32_bf16 v[164:167], a[184:187], v[136:139], 0
    v_mul_f32 v146, v146, v3
    v_mul_f32 v150, v150, v3
    v_mfma_f32_16x16x32_bf16 v[164:167], a[188:191], v[84:87], v[164:167]
    v_mul_f32 v147, v147, v3
    v_mul_f32 v151, v151, v3
    v_cvt_pk_bf16_f32 v168, v144, v148
    v_cvt_pk_bf16_f32 v169, v145, v149
    v_cvt_pk_bf16_f32 v170, v146, v150
    v_cvt_pk_bf16_f32 v171, v147, v151
    v_mul_f32 v152, v152, v3
    v_mul_f32 v156, v156, v3
    v_mfma_f32_16x16x32_bf16 v[172:175], v[168:171], a[72:75], 0
    v_mul_f32 v153, v153, v3
    v_mul_f32 v157, v157, v3
    v_mul_f32 v154, v154, v3
    v_mul_f32 v158, v158, v3
    v_mul_f32 v155, v155, v3
    v_mul_f32 v159, v159, v3
    v_cvt_pk_bf16_f32 v176, v152, v156
    v_cvt_pk_bf16_f32 v177, v153, v157
    v_cvt_pk_bf16_f32 v178, v154, v158
    v_cvt_pk_bf16_f32 v179, v155, v159
    v_mul_f32 v160, v160, v3
    v_mul_f32 v164, v164, v3
    v_mfma_f32_16x16x32_bf16 v[172:175], v[176:179], a[76:79], v[172:175]
    v_mul_f32 v161, v161, v3
    v_mul_f32 v165, v165, v3
    v_mul_f32 v162, v162, v3
    v_mul_f32 v166, v166, v3
    v_mul_f32 v163, v163, v3
    v_mul_f32 v167, v167, v3
    v_cvt_pk_bf16_f32 v180, v160, v164
    v_cvt_pk_bf16_f32 v181, v161, v165
    v_cvt_pk_bf16_f32 v182, v162, v166
    v_cvt_pk_bf16_f32 v183, v163, v167
    s_nop 1
    v_mfma_f32_16x16x32_bf16 v[172:175], v[180:183], a[80:83], v[172:175]
    v_mfma_f32_16x16x32_bf16 v[184:187], v[168:171], a[84:87], 0
    v_mfma_f32_16x16x32_bf16 v[184:187], v[176:179], a[88:91], v[184:187]
    v_mfma_f32_16x16x32_bf16 v[184:187], v[180:183], a[92:95], v[184:187]
    v_mfma_f32_16x16x32_bf16 v[188:191], v[168:171], a[96:99], 0
    v_mfma_f32_16x16x32_bf16 v[188:191], v[176:179], a[100:103], v[188:191]
    v_mfma_f32_16x16x32_bf16 v[188:191], v[180:183], a[104:107], v[188:191]
    v_mfma_f32_16x16x32_bf16 v[192:195], v[168:171], a[108:111], 0
    v_mfma_f32_16x16x32_bf16 v[192:195], v[176:179], a[112:115], v[192:195]
    v_mfma_f32_16x16x32_bf16 v[192:195], v[180:183], a[116:119], v[192:195]
    v_mfma_f32_16x16x32_bf16 v[196:199], v[168:171], a[124:127], 0
    v_mfma_f32_16x16x32_bf16 v[196:199], v[176:179], a[120:123], v[196:199]
    v_cvt_pk_bf16_f32 v200, v172, v184
    v_cvt_pk_bf16_f32 v204, v173, v185
    v_mfma_f32_16x16x32_bf16 v[196:199], v[180:183], a[128:131], v[196:199]
    v_cvt_pk_bf16_f32 v208, v174, v186
    v_cvt_pk_bf16_f32 v212, v175, v187
    v_mfma_f32_16x16x32_bf16 v[216:219], v[168:171], a[132:135], 0
    v_cvt_pk_bf16_f32 v201, v188, v192
    v_cvt_pk_bf16_f32 v205, v189, v193
    v_mfma_f32_16x16x32_bf16 v[216:219], v[176:179], a[136:139], v[216:219]
    v_cvt_pk_bf16_f32 v209, v190, v194
    v_cvt_pk_bf16_f32 v213, v191, v195
    v_mfma_f32_16x16x32_bf16 v[216:219], v[180:183], a[140:143], v[216:219]
    v_mfma_f32_16x16x32_bf16 v[220:223], a[0:3], v[32:35], 0
    v_mfma_f32_16x16x32_bf16 v[220:223], a[4:7], v[36:39], v[220:223]
    v_mfma_f32_16x16x32_bf16 v[220:223], a[8:11], v[40:43], v[220:223]
    v_mfma_f32_16x16x32_bf16 v[224:227], a[12:15], v[32:35], 0
    v_mfma_f32_16x16x32_bf16 v[224:227], a[16:19], v[36:39], v[224:227]
    v_mfma_f32_16x16x32_bf16 v[224:227], a[20:23], v[40:43], v[224:227]
    v_mfma_f32_16x16x32_bf16 v[228:231], a[24:27], v[32:35], 0
    v_mfma_f32_16x16x32_bf16 v[228:231], a[28:31], v[36:39], v[228:231]
    v_cvt_pk_bf16_f32 v202, v196, v216
    v_cvt_pk_bf16_f32 v206, v197, v217
    v_mfma_f32_16x16x32_bf16 v[228:231], a[32:35], v[40:43], v[228:231]
    buffer_store_dwordx3 v[200:202], v5, s[16:19], s30 offen offset:0 sc1 nt
    v_mfma_f32_16x16x32_bf16 v[232:235], a[36:39], v[32:35], 0
    buffer_store_dwordx3 v[204:206], v4, s[16:19], s30 offen offset:768 sc1 nt
    v_mfma_f32_16x16x32_bf16 v[232:235], a[40:43], v[36:39], v[232:235]
    v_cvt_pk_bf16_f32 v210, v198, v218
    v_cvt_pk_bf16_f32 v214, v199, v219
    v_mfma_f32_16x16x32_bf16 v[232:235], a[44:47], v[40:43], v[232:235]
    v_cvt_pk_bf16_f32 v236, v220, v221
    v_cvt_pk_bf16_f32 v237, v222, v223
    v_mfma_f32_16x16x32_bf16 v[240:243], a[48:51], v[32:35], 0
    v_cvt_pk_bf16_f32 v238, v224, v225
    v_cvt_pk_bf16_f32 v239, v226, v227
    v_mfma_f32_16x16x32_bf16 v[240:243], a[52:55], v[36:39], v[240:243]
    buffer_store_dwordx3 v[208:210], v5, s[16:19], s31 offen offset:192 sc1 nt
    v_mfma_f32_16x16x32_bf16 v[240:243], a[56:59], v[40:43], v[240:243]
    v_cvt_pk_bf16_f32 v244, v228, v229
    v_cvt_pk_bf16_f32 v245, v230, v231
    v_mfma_f32_16x16x32_bf16 v[248:251], a[60:63], v[32:35], 0
    v_cvt_pk_bf16_f32 v246, v232, v233
    v_cvt_pk_bf16_f32 v247, v234, v235
    v_mfma_f32_16x16x32_bf16 v[248:251], a[64:67], v[36:39], v[248:251]
    v_mfma_f32_16x16x32_bf16 v[248:251], a[68:71], v[40:43], v[248:251]
    v_mfma_f32_16x16x32_bf16 v[252:255], v[8:11], v[236:239], 0
    v_cvt_pk_bf16_f32 v28, v240, v241
    v_cvt_pk_bf16_f32 v29, v242, v243
    v_mfma_f32_16x16x32_bf16 v[252:255], v[16:19], v[244:247], v[252:255]
    buffer_store_dwordx3 v[212:214], v6, s[16:19], s31 offen offset:960 sc1 nt
    s_nop 2
    v_cvt_pk_bf16_f32 v30, v248, v249
    v_cvt_pk_bf16_f32 v31, v250, v251
    s_nop 1
    v_mfma_f32_16x16x32_bf16 v[252:255], v[24:27], v[28:31], v[252:255]
    v_mfma_f32_16x16x32_bf16 v[72:75], v[32:35], v[236:239], 0
    v_mfma_f32_16x16x32_bf16 v[72:75], v[36:39], v[244:247], v[72:75]
    v_mfma_f32_16x16x32_bf16 v[72:75], v[40:43], v[28:31], v[72:75]
    v_mfma_f32_16x16x32_bf16 v[80:83], v[44:47], v[236:239], 0
    v_mfma_f32_16x16x32_bf16 v[80:83], v[48:51], v[244:247], v[80:83]
    v_mfma_f32_16x16x32_bf16 v[80:83], v[52:55], v[28:31], v[80:83]
    s_nop 1
    v_max3_f32 v3, v7, v252, v253
    v_max3_f32 v3, v3, v254, v255
    s_nop 0
    v_max3_f32 v3, v3, v72, v73
    v_max3_f32 v3, v3, v74, v75
    s_nop 0
    v_max3_f32 v3, v3, v80, v81
    v_max3_f32 v3, v3, v82, v83
    v_mov_b32 v65, v3
    s_nop 1
    v_permlane32_swap_b32 v3, v65
    v_max_f32 v3, v3, v65
    v_mov_b32 v65, v3
    s_nop 1
    v_permlane16_swap_b32 v3, v65
    v_max_f32 v3, v3, v65
    v_sub_f32 v252, v252, v3
    v_sub_f32 v253, v253, v3
    v_sub_f32 v254, v254, v3
    v_sub_f32 v255, v255, v3
    v_sub_f32 v72, v72, v3
    v_sub_f32 v73, v73, v3
    v_sub_f32 v74, v74, v3
    v_sub_f32 v75, v75, v3
    v_exp_f32 v252, v252
    v_exp_f32 v253, v253
    v_exp_f32 v254, v254
    v_exp_f32 v255, v255
    v_exp_f32 v72, v72
    v_exp_f32 v73, v73
    v_exp_f32 v74, v74
    v_exp_f32 v75, v75
    v_cvt_pk_bf16_f32 v100, v252, v253
    v_cvt_pk_bf16_f32 v101, v254, v255
    v_cvt_pk_bf16_f32 v102, v72, v73
    v_cvt_pk_bf16_f32 v103, v74, v75
    v_sub_f32 v80, v80, v3
    v_sub_f32 v81, v81, v3
    v_mfma_f32_16x16x32_bf16 v[104:107], v[76:79], v[100:103], 0
    v_sub_f32 v82, v82, v3
    v_sub_f32 v83, v83, v3
    v_sub_f32 v7, v7, v3
    v_exp_f32 v80, v80
    v_exp_f32 v81, v81
    v_exp_f32 v82, v82
    v_exp_f32 v83, v83
    v_exp_f32 v7, v7
    v_cvt_pk_bf16_f32 v88, v80, v81
    v_cvt_pk_bf16_f32 v89, v82, v83
    v_cvt_pk_bf16_f32 v90, v7, 0
    s_nop 1
    v_mfma_f32_16x16x32_bf16 v[104:107], v[76:79], v[88:91], v[104:107]
    v_mfma_f32_16x16x32_bf16 v[112:115], a[144:147], v[100:103], 0
    v_mfma_f32_16x16x32_bf16 v[112:115], a[148:151], v[88:91], v[112:115]
    v_mfma_f32_16x16x32_bf16 v[116:119], a[152:155], v[100:103], 0
    v_mfma_f32_16x16x32_bf16 v[116:119], a[156:159], v[88:91], v[116:119]
    v_mfma_f32_16x16x32_bf16 v[92:95], a[160:163], v[100:103], 0
    v_mfma_f32_16x16x32_bf16 v[92:95], a[164:167], v[88:91], v[92:95]
    v_mfma_f32_16x16x32_bf16 v[108:111], a[168:171], v[100:103], 0
    v_mfma_f32_16x16x32_bf16 v[108:111], a[172:175], v[88:91], v[108:111]
    v_rcp_f32 v3, v104
    v_mfma_f32_16x16x32_bf16 v[120:123], a[176:179], v[100:103], 0
    v_mul_f32 v112, v112, v3
    v_mul_f32 v113, v113, v3
    v_mfma_f32_16x16x32_bf16 v[120:123], a[180:183], v[88:91], v[120:123]
    v_mul_f32 v116, v116, v3
    v_mul_f32 v117, v117, v3
    v_mfma_f32_16x16x32_bf16 v[124:127], a[184:187], v[100:103], 0
    v_mul_f32 v114, v114, v3
    v_mul_f32 v118, v118, v3
    v_mfma_f32_16x16x32_bf16 v[124:127], a[188:191], v[88:91], v[124:127]
    v_mul_f32 v115, v115, v3
    v_mul_f32 v119, v119, v3
    v_cvt_pk_bf16_f32 v128, v112, v116
    v_cvt_pk_bf16_f32 v129, v113, v117
    v_cvt_pk_bf16_f32 v130, v114, v118
    v_cvt_pk_bf16_f32 v131, v115, v119
    v_mul_f32 v92, v92, v3
    v_mul_f32 v108, v108, v3
    v_mfma_f32_16x16x32_bf16 v[132:135], v[128:131], a[72:75], 0
    v_mul_f32 v93, v93, v3
    v_mul_f32 v109, v109, v3
    v_mul_f32 v94, v94, v3
    v_mul_f32 v110, v110, v3
    v_mul_f32 v95, v95, v3
    v_mul_f32 v111, v111, v3
    v_cvt_pk_bf16_f32 v140, v92, v108
    v_cvt_pk_bf16_f32 v141, v93, v109
    v_cvt_pk_bf16_f32 v142, v94, v110
    v_cvt_pk_bf16_f32 v143, v95, v111
    v_mul_f32 v120, v120, v3
    v_mul_f32 v124, v124, v3
    v_mfma_f32_16x16x32_bf16 v[132:135], v[140:143], a[76:79], v[132:135]
    v_mul_f32 v121, v121, v3
    v_mul_f32 v125, v125, v3
    v_mul_f32 v122, v122, v3
    v_mul_f32 v126, v126, v3
    v_mul_f32 v123, v123, v3
    v_mul_f32 v127, v127, v3
    v_cvt_pk_bf16_f32 v136, v120, v124
    v_cvt_pk_bf16_f32 v137, v121, v125
    v_cvt_pk_bf16_f32 v138, v122, v126
    v_cvt_pk_bf16_f32 v139, v123, v127
    s_nop 1
    v_mfma_f32_16x16x32_bf16 v[132:135], v[136:139], a[80:83], v[132:135]
    v_mfma_f32_16x16x32_bf16 v[84:87], v[128:131], a[84:87], 0
    v_mfma_f32_16x16x32_bf16 v[84:87], v[140:143], a[88:91], v[84:87]
    v_mfma_f32_16x16x32_bf16 v[84:87], v[136:139], a[92:95], v[84:87]
    v_mfma_f32_16x16x32_bf16 v[144:147], v[128:131], a[96:99], 0
    v_mfma_f32_16x16x32_bf16 v[144:147], v[140:143], a[100:103], v[144:147]
    v_mfma_f32_16x16x32_bf16 v[144:147], v[136:139], a[104:107], v[144:147]
    v_mfma_f32_16x16x32_bf16 v[148:151], v[128:131], a[108:111], 0
    v_mfma_f32_16x16x32_bf16 v[148:151], v[140:143], a[112:115], v[148:151]
    v_mfma_f32_16x16x32_bf16 v[148:151], v[136:139], a[116:119], v[148:151]
    v_mfma_f32_16x16x32_bf16 v[152:155], v[128:131], a[124:127], 0
    v_mfma_f32_16x16x32_bf16 v[152:155], v[140:143], a[120:123], v[152:155]
    v_cvt_pk_bf16_f32 v156, v132, v84
    v_cvt_pk_bf16_f32 v160, v133, v85
    v_mfma_f32_16x16x32_bf16 v[152:155], v[136:139], a[128:131], v[152:155]
    v_cvt_pk_bf16_f32 v164, v134, v86
    v_cvt_pk_bf16_f32 v172, v135, v87
    v_mfma_f32_16x16x32_bf16 v[184:187], v[128:131], a[132:135], 0
    v_cvt_pk_bf16_f32 v157, v144, v148
    v_cvt_pk_bf16_f32 v161, v145, v149
    v_mfma_f32_16x16x32_bf16 v[184:187], v[140:143], a[136:139], v[184:187]
    v_cvt_pk_bf16_f32 v165, v146, v150
    v_cvt_pk_bf16_f32 v173, v147, v151
    v_mfma_f32_16x16x32_bf16 v[184:187], v[136:139], a[140:143], v[184:187]
    v_mfma_f32_16x16x32_bf16 v[188:191], a[0:3], v[44:47], 0
    v_mfma_f32_16x16x32_bf16 v[188:191], a[4:7], v[48:51], v[188:191]
    v_mfma_f32_16x16x32_bf16 v[188:191], a[8:11], v[52:55], v[188:191]
    v_mfma_f32_16x16x32_bf16 v[192:195], a[12:15], v[44:47], 0
    v_mfma_f32_16x16x32_bf16 v[192:195], a[16:19], v[48:51], v[192:195]
    v_mfma_f32_16x16x32_bf16 v[192:195], a[20:23], v[52:55], v[192:195]
    v_mfma_f32_16x16x32_bf16 v[168:171], a[24:27], v[44:47], 0
    v_mfma_f32_16x16x32_bf16 v[168:171], a[28:31], v[48:51], v[168:171]
    v_cvt_pk_bf16_f32 v158, v152, v184
    v_cvt_pk_bf16_f32 v162, v153, v185
    v_mfma_f32_16x16x32_bf16 v[168:171], a[32:35], v[52:55], v[168:171]
    buffer_store_dwordx3 v[156:158], v5, s[16:19], s32 offen offset:384 sc1 nt
    v_mfma_f32_16x16x32_bf16 v[176:179], a[36:39], v[44:47], 0
    buffer_store_dwordx3 v[160:162], v64, s[16:19], s32 offen offset:1152 sc1 nt
    v_mfma_f32_16x16x32_bf16 v[176:179], a[40:43], v[48:51], v[176:179]
    v_cvt_pk_bf16_f32 v166, v154, v186
    v_cvt_pk_bf16_f32 v174, v155, v187
    v_mfma_f32_16x16x32_bf16 v[176:179], a[44:47], v[52:55], v[176:179]
    v_cvt_pk_bf16_f32 v180, v188, v189
    v_cvt_pk_bf16_f32 v181, v190, v191
    v_mfma_f32_16x16x32_bf16 v[200:203], a[48:51], v[44:47], 0
    v_cvt_pk_bf16_f32 v182, v192, v193
    v_cvt_pk_bf16_f32 v183, v194, v195
    v_mfma_f32_16x16x32_bf16 v[200:203], a[52:55], v[48:51], v[200:203]
    buffer_store_dwordx3 v[164:166], v5, s[16:19], s33 offen offset:576 sc1 nt
    v_mfma_f32_16x16x32_bf16 v[200:203], a[56:59], v[52:55], v[200:203]
    v_cvt_pk_bf16_f32 v204, v168, v169
    v_cvt_pk_bf16_f32 v205, v170, v171
    v_mfma_f32_16x16x32_bf16 v[196:199], a[60:63], v[44:47], 0
    v_cvt_pk_bf16_f32 v206, v176, v177
    v_cvt_pk_bf16_f32 v207, v178, v179
    v_mfma_f32_16x16x32_bf16 v[196:199], a[64:67], v[48:51], v[196:199]
    v_mfma_f32_16x16x32_bf16 v[196:199], a[68:71], v[52:55], v[196:199]
    v_mfma_f32_16x16x32_bf16 v[216:219], v[8:11], v[180:183], 0
    v_cvt_pk_bf16_f32 v220, v200, v201
    v_cvt_pk_bf16_f32 v221, v202, v203
    v_mfma_f32_16x16x32_bf16 v[216:219], v[16:19], v[204:207], v[216:219]
    buffer_store_dwordx3 v[172:174], v5, s[16:19], s34 offen offset:0 sc1 nt
    ds_read_b128 v[224:227], v67 offset:704
    s_nop 1
    v_cvt_pk_bf16_f32 v222, v196, v197
    v_cvt_pk_bf16_f32 v223, v198, v199
    s_nop 1
    v_mfma_f32_16x16x32_bf16 v[216:219], v[24:27], v[220:223], v[216:219]
    v_mfma_f32_16x16x32_bf16 v[208:211], v[32:35], v[180:183], 0
    v_mfma_f32_16x16x32_bf16 v[208:211], v[36:39], v[204:207], v[208:211]
    v_mfma_f32_16x16x32_bf16 v[208:211], v[40:43], v[220:223], v[208:211]
    v_mfma_f32_16x16x32_bf16 v[228:231], v[44:47], v[180:183], 0
    v_mfma_f32_16x16x32_bf16 v[228:231], v[48:51], v[204:207], v[228:231]
    s_waitcnt lgkmcnt(0)
    v_add_f32 v224, v224, v225
    v_add_f32 v224, v224, v226
    v_mfma_f32_16x16x32_bf16 v[228:231], v[52:55], v[220:223], v[228:231]
    v_max3_f32 v3, v14, v216, v217
    v_max3_f32 v3, v3, v218, v219
    v_max3_f32 v3, v3, v208, v209
    v_max3_f32 v3, v3, v210, v211
    v_cndmask_b32 v7, v2, v224, s[56:57]
    v_cndmask_b32 v7, v7, v57, s[50:51]
    v_cndmask_b32 v7, v7, v61, s[52:53]
    v_cndmask_b32 v7, v7, v69, s[54:55]
    v_max3_f32 v3, v3, v228, v229
    v_max3_f32 v3, v3, v230, v231
    v_mov_b32 v2, v3
    v_max_f32_dpp v21, v7, v7 row_ror:8 row_mask:0xf bank_mask:0xf
    s_nop 0
    v_permlane32_swap_b32 v3, v2
    v_max_f32 v3, v3, v2
    v_mov_b32 v2, v3
    v_max_f32_dpp v21, v21, v21 row_ror:4 row_mask:0xf bank_mask:0xf
    s_nop 0
    v_permlane16_swap_b32 v3, v2
    v_max_f32 v3, v3, v2
    v_sub_f32 v216, v216, v3
    v_sub_f32 v217, v217, v3
    v_sub_f32 v218, v218, v3
    v_sub_f32 v219, v219, v3
    v_sub_f32 v208, v208, v3
    v_sub_f32 v209, v209, v3
    v_sub_f32 v210, v210, v3
    v_sub_f32 v211, v211, v3
    v_exp_f32 v216, v216
    v_exp_f32 v217, v217
    v_exp_f32 v218, v218
    v_exp_f32 v219, v219
    v_exp_f32 v208, v208
    v_exp_f32 v209, v209
    v_exp_f32 v210, v210
    v_exp_f32 v211, v211
    v_cvt_pk_bf16_f32 v232, v216, v217
    v_cvt_pk_bf16_f32 v233, v218, v219
    v_cvt_pk_bf16_f32 v234, v208, v209
    v_cvt_pk_bf16_f32 v235, v210, v211
    v_sub_f32 v228, v228, v3
    v_sub_f32 v229, v229, v3
    v_mfma_f32_16x16x32_bf16 v[240:243], v[76:79], v[232:235], 0
    v_sub_f32 v230, v230, v3
    v_sub_f32 v231, v231, v3
    v_sub_f32 v14, v14, v3
    v_exp_f32 v228, v228
    v_exp_f32 v229, v229
    v_exp_f32 v230, v230
    v_exp_f32 v231, v231
    v_exp_f32 v14, v14
    v_cvt_pk_bf16_f32 v96, v228, v229
    v_cvt_pk_bf16_f32 v97, v230, v231
    v_cvt_pk_bf16_f32 v98, v14, 0
    v_max_f32_dpp v21, v21, v21 row_ror:2 row_mask:0xf bank_mask:0xf
    s_nop 0
    v_mfma_f32_16x16x32_bf16 v[240:243], v[76:79], v[96:99], v[240:243]
    v_max_f32_dpp v21, v21, v21 row_ror:1 row_mask:0xf bank_mask:0xf
    v_mov_b32 v14, v21
    v_mfma_f32_16x16x32_bf16 v[212:215], a[144:147], v[232:235], 0
    v_mfma_f32_16x16x32_bf16 v[212:215], a[148:151], v[96:99], v[212:215]
    v_permlane32_swap_b32 v21, v14
    v_mfma_f32_16x16x32_bf16 v[248:251], a[152:155], v[232:235], 0
    v_max_f32 v21, v21, v14
    v_mov_b32 v14, v21
    v_mfma_f32_16x16x32_bf16 v[248:251], a[156:159], v[96:99], v[248:251]
    v_rcp_f32 v2, v240
    v_mfma_f32_16x16x32_bf16 v[236:239], a[160:163], v[232:235], 0
    v_permlane16_swap_b32 v21, v14
    v_mfma_f32_16x16x32_bf16 v[236:239], a[164:167], v[96:99], v[236:239]
    v_mul_f32 v212, v212, v2
    v_mul_f32 v213, v213, v2
    v_mfma_f32_16x16x32_bf16 v[244:247], a[168:171], v[232:235], 0
    v_mul_f32 v214, v214, v2
    v_mul_f32 v248, v248, v2
    v_mfma_f32_16x16x32_bf16 v[244:247], a[172:175], v[96:99], v[244:247]
    v_mul_f32 v249, v249, v2
    v_mul_f32 v250, v250, v2
    v_mfma_f32_16x16x32_bf16 v[28:31], a[176:179], v[232:235], 0
    v_mul_f32 v215, v215, v2
    v_mul_f32 v251, v251, v2
    v_mfma_f32_16x16x32_bf16 v[28:31], a[180:183], v[96:99], v[28:31]
    v_cvt_pk_bf16_f32 v252, v212, v248
    v_cvt_pk_bf16_f32 v253, v213, v249
    v_mfma_f32_16x16x32_bf16 v[72:75], a[184:187], v[232:235], 0
    v_cvt_pk_bf16_f32 v254, v214, v250
    v_cvt_pk_bf16_f32 v255, v215, v251
    v_mfma_f32_16x16x32_bf16 v[72:75], a[188:191], v[96:99], v[72:75]
    v_mul_f32 v236, v236, v2
    v_mul_f32 v244, v244, v2
    v_mfma_f32_16x16x32_bf16 v[80:83], v[252:255], a[72:75], 0
    v_mul_f32 v237, v237, v2
    v_mul_f32 v245, v245, v2
    v_mul_f32 v238, v238, v2
    v_mul_f32 v246, v246, v2
    v_mul_f32 v239, v239, v2
    v_mul_f32 v247, v247, v2
    v_cvt_pk_bf16_f32 v104, v236, v244
    v_cvt_pk_bf16_f32 v105, v237, v245
    v_cvt_pk_bf16_f32 v106, v238, v246
    v_cvt_pk_bf16_f32 v107, v239, v247
    v_mul_f32 v28, v28, v2
    v_mul_f32 v72, v72, v2
    v_mfma_f32_16x16x32_bf16 v[80:83], v[104:107], a[76:79], v[80:83]
    v_mul_f32 v29, v29, v2
    v_mul_f32 v73, v73, v2
    v_mul_f32 v30, v30, v2
    v_mul_f32 v74, v74, v2
    v_mul_f32 v31, v31, v2
    v_mul_f32 v75, v75, v2
    v_cvt_pk_bf16_f32 v100, v28, v72
    v_cvt_pk_bf16_f32 v101, v29, v73
    v_cvt_pk_bf16_f32 v102, v30, v74
    v_cvt_pk_bf16_f32 v103, v31, v75
    v_max_f32 v21, v21, v14
    v_sub_f32 v7, v7, v21
    v_mfma_f32_16x16x32_bf16 v[80:83], v[100:103], a[80:83], v[80:83]
    v_exp_f32 v7, v7
    v_mfma_f32_16x16x32_bf16 v[88:91], v[252:255], a[84:87], 0
    v_cvt_pk_bf16_f32 v7, v7, v7
    v_mfma_f32_16x16x32_bf16 v[88:91], v[104:107], a[88:91], v[88:91]
    ds_write_b16 v12, v7 offset:576
    v_mfma_f32_16x16x32_bf16 v[88:91], v[100:103], a[92:95], v[88:91]
    ds_read2_b64 v[112:115], v13 offset0:72 offset1:76
    v_mfma_f32_16x16x32_bf16 v[116:119], v[252:255], a[96:99], 0
    ds_read2_b64 v[92:95], v13 offset0:80 offset1:84
    v_mfma_f32_16x16x32_bf16 v[116:119], v[104:107], a[100:103], v[116:119]
    v_mfma_f32_16x16x32_bf16 v[116:119], v[100:103], a[104:107], v[116:119]
    v_mfma_f32_16x16x32_bf16 v[108:111], v[252:255], a[108:111], 0
    v_mfma_f32_16x16x32_bf16 v[108:111], v[104:107], a[112:115], v[108:111]
    v_mfma_f32_16x16x32_bf16 v[108:111], v[100:103], a[116:119], v[108:111]
    v_cvt_pk_bf16_f32 v120, v80, v88
    v_cvt_pk_bf16_f32 v124, v81, v89
    v_mfma_f32_16x16x32_bf16 v[84:87], v[252:255], a[124:127], 0
    v_cvt_pk_bf16_f32 v132, v82, v90
    v_cvt_pk_bf16_f32 v144, v83, v91
    v_mfma_f32_16x16x32_bf16 v[84:87], v[104:107], a[120:123], v[84:87]
    v_mfma_f32_16x16x32_bf16 v[84:87], v[100:103], a[128:131], v[84:87]
    v_mfma_f32_16x16x32_bf16 v[148:151], v[252:255], a[132:135], 0
    v_cvt_pk_bf16_f32 v121, v116, v108
    v_cvt_pk_bf16_f32 v125, v117, v109
    v_mfma_f32_16x16x32_bf16 v[148:151], v[104:107], a[136:139], v[148:151]
    s_waitcnt lgkmcnt(0)
    v_cvt_pk_bf16_f32 v133, v118, v110
    v_cvt_pk_bf16_f32 v145, v119, v111
    v_mfma_f32_16x16x32_bf16 v[148:151], v[100:103], a[140:143], v[148:151]
    v_mfma_f32_16x16x32_bf16 v[128:131], v[112:115], v[76:79], 0
    v_mfma_f32_16x16x32_bf16 v[128:131], v[92:95], v[76:79], v[128:131]
    v_mfma_f32_16x16x32_bf16 v[140:143], v[112:115], a[144:147], 0
    v_mfma_f32_16x16x32_bf16 v[140:143], v[92:95], a[148:151], v[140:143]
    v_mfma_f32_16x16x32_bf16 v[136:139], v[112:115], a[152:155], 0
    v_mfma_f32_16x16x32_bf16 v[136:139], v[92:95], a[156:159], v[136:139]
    v_mfma_f32_16x16x32_bf16 v[156:159], v[112:115], a[160:163], 0
    v_mfma_f32_16x16x32_bf16 v[156:159], v[92:95], a[164:167], v[156:159]
    v_cvt_pk_bf16_f32 v122, v84, v148
    v_cvt_pk_bf16_f32 v126, v85, v149
    v_mfma_f32_16x16x32_bf16 v[160:163], v[112:115], a[168:171], 0
    buffer_store_dwordx3 v[120:122], v4, s[16:19], s34 offen offset:768 sc1 nt
    v_mfma_f32_16x16x32_bf16 v[160:163], v[92:95], a[172:175], v[160:163]
    buffer_store_dwordx3 v[124:126], v5, s[16:19], s35 offen offset:192 sc1 nt
    v_mfma_f32_16x16x32_bf16 v[152:155], v[112:115], a[176:179], 0
    v_cvt_pk_bf16_f32 v2, v140, v136
    v_cvt_pk_bf16_f32 v134, v86, v150
    v_mfma_f32_16x16x32_bf16 v[152:155], v[92:95], a[180:183], v[152:155]
    ds_write_b32 v1, v2 offset:384
    v_mfma_f32_16x16x32_bf16 v[184:187], v[112:115], a[184:187], 0
    v_cvt_pk_bf16_f32 v146, v87, v151
    v_cvt_pk_bf16_f32 v2, v156, v160
    v_mfma_f32_16x16x32_bf16 v[184:187], v[92:95], a[188:191], v[184:187]
    ds_write_b32 v1, v2 offset:448
    v_mov_b32 v2, v128
    buffer_store_dwordx3 v[132:134], v6, s[16:19], s35 offen offset:960 sc1 nt
    buffer_store_dwordx3 v[144:146], v5, s[16:19], s36 offen offset:384 sc1 nt
    v_rcp_f32 v3, v2
    s_nop 2
    v_cvt_pk_bf16_f32 v2, v152, v184
    ds_write_b32 v1, v2 offset:512
    ds_read_b128 v[188:191], v15 offset:384
    ds_read_b128 v[192:195], v15 offset:448
    ds_read_b128 v[164:167], v15 offset:512
    s_waitcnt lgkmcnt(2)
    v_mfma_f32_16x16x32_bf16 v[168:171], v[188:191], a[72:75], 0
    s_waitcnt lgkmcnt(1)
    v_mfma_f32_16x16x32_bf16 v[168:171], v[192:195], a[76:79], v[168:171]
    s_waitcnt lgkmcnt(0)
    v_mfma_f32_16x16x32_bf16 v[168:171], v[164:167], a[80:83], v[168:171]
    v_mfma_f32_16x16x32_bf16 v[176:179], v[188:191], a[84:87], 0
    v_mfma_f32_16x16x32_bf16 v[176:179], v[192:195], a[88:91], v[176:179]
    v_mfma_f32_16x16x32_bf16 v[176:179], v[164:167], a[92:95], v[176:179]
    v_mfma_f32_16x16x32_bf16 v[200:203], v[188:191], a[96:99], 0
    v_mfma_f32_16x16x32_bf16 v[200:203], v[192:195], a[100:103], v[200:203]
    v_mfma_f32_16x16x32_bf16 v[200:203], v[164:167], a[104:107], v[200:203]
    v_mfma_f32_16x16x32_bf16 v[172:175], v[188:191], a[108:111], 0
    v_mfma_f32_16x16x32_bf16 v[172:175], v[192:195], a[112:115], v[172:175]
    v_mul_f32 v168, v168, v3
    v_mfma_f32_16x16x32_bf16 v[172:175], v[164:167], a[116:119], v[172:175]
    v_mfma_f32_16x16x32_bf16 v[64:67], v[188:191], a[124:127], 0
    v_mul_f32 v176, v176, v3
    v_cvt_pk_bf16_f32 v8, v168, v176
    v_mfma_f32_16x16x32_bf16 v[64:67], v[192:195], a[120:123], v[64:67]
    v_mul_f32 v200, v200, v3
    v_mfma_f32_16x16x32_bf16 v[64:67], v[164:167], a[128:131], v[64:67]
    v_mfma_f32_16x16x32_bf16 v[196:199], v[188:191], a[132:135], 0
    v_mfma_f32_16x16x32_bf16 v[196:199], v[192:195], a[136:139], v[196:199]
    v_mul_f32 v172, v172, v3
    v_cvt_pk_bf16_f32 v9, v200, v172
    v_mfma_f32_16x16x32_bf16 v[196:199], v[164:167], a[140:143], v[196:199]
    s_nop 2
    v_mul_f32 v64, v64, v3
    s_nop 3
    v_mul_f32 v196, v196, v3
    v_cvt_pk_bf16_f32 v10, v64, v196
    buffer_store_dwordx3 v[8:10], v20, s[16:19], s61 offen sc1 nt
    s_add_u32 s30, s30, 9144576
    s_add_u32 s60, s60, 36864
    s_add_u32 s38, s38, 2880
    s_add_u32 s39, s39, 192
    s_add_u32 s61, s61, 9144576
    s_add_u32 s63, s63, 1
    s_cmp_lt_u32 s63, 3
    s_cbranch_scc1 L_slow1
    s_branch L_done
L_end:
    s_endpgm
.section .rodata,"a"
.p2align 6
.amdhsa_kernel standalone__swin_window_attn__vision_kernel
  .amdhsa_next_free_vgpr 512
  .amdhsa_next_free_sgpr 102
  .amdhsa_accum_offset 256
  .amdhsa_group_segment_fixed_size 0
  .amdhsa_kernarg_size 48
  .amdhsa_user_sgpr_count 2
  .amdhsa_user_sgpr_kernarg_segment_ptr 1
  .amdhsa_system_sgpr_workgroup_id_x 1
.end_amdhsa_kernel
```
